```python
import torch

def _softmax(x, axis=-1):
    return torch.softmax(x, dim=axis)
def _gelu(x):
    return torch.nn.functional.gelu(x, approximate="tanh")
def _silu(x):
    return torch.nn.functional.silu(x)
def _sigmoid(x):
    return torch.sigmoid(x)
def _layernorm(x, axis=-1, eps=1e-5):
    m = x.mean(dim=axis, keepdim=True)
    v = x.var(dim=axis, keepdim=True, unbiased=False)
    return (x - m) / torch.sqrt(v + eps)
def _scatter_add(tgt, idx, src, axis=0):
    return tgt.clone().index_add_(axis, idx, src)
def _segment_sum(src, seg, n):
    out = torch.zeros((n,) + src.shape[1:], dtype=src.dtype)
    return out.index_add_(0, seg, src)
def _pad(x, pw):
    flat = tuple(v for pair in reversed(pw) for v in pair)
    return torch.nn.functional.pad(x, flat)

kernel_name = 'sequential_preLN__sliding_block__mixer_channel_mlp__prompt'

def setup_inputs():

    _w = (lambda a: (lambda t: t.to(torch.bfloat16) if t.is_floating_point() else t)(torch.as_tensor(a)))
    def _A_setup():
        B, S, D = 1, 2048, 1024
        return {
            "x": _w((lambda *s: torch.randn(*s, dtype=torch.bfloat16) * 0.05)(B, S, D)),
            "wqkv": _w((lambda *s: torch.randn(*s, dtype=torch.bfloat16) * 0.05)(D, 3 * D)),
            "wo": _w((lambda *s: torch.randn(*s, dtype=torch.bfloat16) * 0.05)(D, D)),
        }
    _A_in = _A_setup()

    def _B_setup():
        B, S, D, F = 1, 2048, 1024, 3584
        return {
            "x": _w((lambda *s: torch.randn(*s, dtype=torch.bfloat16) * 0.05)(B, S, D)),
            "w1": _w((lambda *s: torch.randn(*s, dtype=torch.bfloat16) * 3.2)(D, F) * (D ** -0.5)),
            "b1": _w((lambda *s: torch.randn(*s, dtype=torch.bfloat16) * 1.6)(F)),
            "w2": _w((lambda *s: torch.randn(*s, dtype=torch.bfloat16) * 0.4)(F, D) * (F ** -0.5)),
            "b2": _w((lambda *s: torch.randn(*s, dtype=torch.bfloat16) * 0.8)(D)),
        }
    _B_in = _B_setup()

    return {
        "A_x": _A_in["x"],
        "A_wqkv": _A_in["wqkv"],
        "A_wo": _A_in["wo"],
        "B_x": _B_in["x"],
        "B_w1": _B_in["w1"],
        "B_b1": _B_in["b1"],
        "B_w2": _B_in["w2"],
        "B_b2": _B_in["b2"],
    }

def reference(A_x, A_wqkv, A_wo, B_x, B_w1, B_b1, B_w2, B_b2):
    def _A_ref(x, wqkv, wo):
        B, S, D = x.shape
        H = 32; Dh = D // H; W = 256
        qkv = (lambda x, *d: x.permute(*d))((x @ wqkv).reshape(B, S, 3, H, Dh), 2, 0, 3, 1, 4)
        q, k, v = qkv[0], qkv[1], qkv[2]
        scores = torch.einsum("bhqd,bhkd->bhqk", q, k) * (Dh ** -0.5)
        idx = torch.arange(S)
        mask = (idx[:, None] - idx[None, :] >= 0) & (idx[:, None] - idx[None, :] < W)
        scores = torch.where(mask[None, None], scores, -1e9)
        p = _softmax(scores, axis=-1)
        o = torch.einsum("bhqk,bhkd->bhqd", p, v)
        return (lambda x, *d: x.permute(*d))(o, 0, 2, 1, 3).reshape(B, S, D) @ wo

    def _B_ref(x, w1, b1, w2, b2):
        y = _layernorm(x, axis=-1)
        h = _gelu(torch.einsum("bsd,df->bsf", y, w1) + b1)
        return torch.einsum("bsf,fd->bsd", h, w2) + b2

    x = A_x
    h = x + _A_ref(_layernorm(x, axis=-1), A_wqkv, A_wo)
    h2 = h + _B_ref(_layernorm(h, axis=-1), B_w1, B_b1, B_w2, B_b2)
    return h2
```

```asm
; @launch kernel=qkv_kernel grid=(256,1,1) block=(512,1,1) lds=163840
; @launch kernel=attn_kernel grid=(256,1,1) block=(512,1,1) lds=72704
; @launch kernel=wo_kernel grid=(256,1,1) block=(512,1,1) lds=147456
; @launch kernel=w1_kernel grid=(256,1,1) block=(512,1,1) lds=148480
; @launch kernel=w2_kernel grid=(256,1,1) block=(512,1,1) lds=147456
.amdgcn_target "amdgcn-amd-amdhsa--gfx950"
.text
.globl qkv_kernel
.p2align 8
.type qkv_kernel,@function
qkv_kernel:
    s_cmp_ge_u32 s2, 256
    s_cbranch_scc1 qkv_kernel_end
    s_load_dwordx2 s[4:5], s[0:1], 0
    s_load_dwordx2 s[8:9], s[0:1], 8
    s_load_dwordx2 s[12:13], s[0:1], 80
    s_load_dwordx2 s[44:45], s[0:1], 80
    s_load_dwordx2 s[48:49], s[0:1], 80
    s_load_dwordx2 s[56:57], s[0:1], 72
    s_and_b32 s27, s2, 7
    s_lshr_b32 s28, s2, 3
    s_and_b32 s29, s27, 1
    s_lshl_b32 s29, s29, 3
    s_and_b32 s30, s28, 7
    s_add_u32 s29, s29, s30
    s_lshr_b32 s30, s27, 1
    s_lshl_b32 s30, s30, 2
    s_lshr_b32 s31, s28, 3
    s_add_u32 s30, s30, s31
    s_mov_b32 s41, 0

    s_lshl_b32 s24, s29, 7
    s_mul_i32 s25, s30, 192
    v_lshrrev_b32 v1, 6, v0
    v_and_b32 v0, 63, v0
    s_mov_b32 s40, 40960
    v_readfirstlane_b32 s26, v1

    v_cmp_le_u32 vcc, 24, v0
    v_mov_b32 v1, 0
    s_nop 1
    v_cndmask_b32 v1, 0, 1, vcc
    v_mul_u32_u24 v2, 24, v1
    v_sub_u32 v195, v0, v2

    s_lshl_b32 s32, s26, 4
    v_add_u32 v1, s32, v1
    s_mul_i32 s34, s41, 192
    s_add_u32 s33, s25, s34
    s_mov_b32 s35, 784
    v_mul_lo_u32 v192, v1, s35
    v_lshl_add_u32 v192, v195, 5, v192
    s_lshl_b32 s34, s34, 2
    v_add_u32 v192, s34, v192
    v_add_u32 v2, s24, v1
    v_lshlrev_b32 v5, 4, v195
    s_lshl_b32 s34, s33, 1
    v_add_u32 v5, s34, v5

    v_lshrrev_b32 v6, 6, v5
    v_lshlrev_b32 v6, 11, v6
    v_add_u32 v6, v6, v2
    v_lshlrev_b32 v6, 6, v6
    v_and_b32 v7, 63, v5
    v_add_u32 v193, v6, v7

    v_lshlrev_b32 v194, 3, v1
    v_add_u32 v194, 101376, v194

    s_waitcnt lgkmcnt(0)
    s_and_b32 s5, s5, 0xffff
    s_mov_b32 s6, 4194304
    s_mov_b32 s7, 0x00020000
    s_and_b32 s9, s9, 0xffff
    s_mov_b32 s10, 6291456
    s_mov_b32 s11, 0x00020000
    s_add_u32 s12, s12, 4194304
    s_addc_u32 s13, s13, 0
    s_and_b32 s13, s13, 0xffff
    s_mov_b32 s14, 12582912
    s_mov_b32 s15, 0x00020000
    s_add_u32 s44, s44, 48234496
    s_addc_u32 s45, s45, 0
    s_and_b32 s45, s45, 0xffff
    s_mov_b32 s46, 16384
    s_mov_b32 s47, 0x00020000
    s_add_u32 s48, s48, 49283072
    s_addc_u32 s49, s49, 0
    s_and_b32 s49, s49, 0xffff
    s_mov_b32 s50, 196608
    s_mov_b32 s51, 0x00020000
    s_and_b32 s57, s57, 0xffff
    s_mov_b32 s58, 256
    s_mov_b32 s59, 0x00020000
    s_cmp_ge_u32 s26, 4
    s_cbranch_scc1 qkv_kernel_prod
    s_and_b32 s30, s26, 1
    s_lshr_b32 s31, s26, 1
    v_and_b32 v1, 15, v0
    v_lshrrev_b32 v2, 4, v0

    v_lshrrev_b32 v3, 1, v1
    v_xor_b32 v3, v3, v2
    v_lshlrev_b32 v3, 4, v3
    s_lshl_b32 s32, s30, 13
    v_lshlrev_b32 v4, 7, v1
    v_add_u32 v4, s32, v4
    v_add_u32 v88, v4, v3
    v_xor_b32 v89, 64, v88

    v_lshrrev_b32 v3, 2, v1
    v_lshrrev_b32 v4, 1, v3
    v_and_b32 v5, 1, v2
    v_lshlrev_b32 v5, 1, v5
    v_or_b32 v4, v4, v5
    v_lshlrev_b32 v5, 3, v2
    v_add_u32 v5, v5, v3
    v_lshlrev_b32 v5, 7, v5
    v_and_b32 v6, 3, v0
    v_lshlrev_b32 v6, 3, v6
    v_add_u32 v5, v5, v6
    v_add_u32 v5, 16384, v5
    s_mul_i32 s32, s31, 6

    s_add_u32 s33, s32, 0
    s_lshr_b32 s34, s33, 2
    s_lshl_b32 s34, s34, 13
    s_and_b32 s33, s33, 3
    v_xor_b32 v6, s33, v4
    v_lshlrev_b32 v6, 5, v6
    v_add_u32 v6, s34, v6
    v_add_u32 v90, v6, v5

    s_add_u32 s33, s32, 1
    s_lshr_b32 s34, s33, 2
    s_lshl_b32 s34, s34, 13
    s_and_b32 s33, s33, 3
    v_xor_b32 v6, s33, v4
    v_lshlrev_b32 v6, 5, v6
    v_add_u32 v6, s34, v6
    v_add_u32 v91, v6, v5

    s_add_u32 s33, s32, 2
    s_lshr_b32 s34, s33, 2
    s_lshl_b32 s34, s34, 13
    s_and_b32 s33, s33, 3
    v_xor_b32 v6, s33, v4
    v_lshlrev_b32 v6, 5, v6
    v_add_u32 v6, s34, v6
    v_add_u32 v92, v6, v5

    s_add_u32 s33, s32, 3
    s_lshr_b32 s34, s33, 2
    s_lshl_b32 s34, s34, 13
    s_and_b32 s33, s33, 3
    v_xor_b32 v6, s33, v4
    v_lshlrev_b32 v6, 5, v6
    v_add_u32 v6, s34, v6
    v_add_u32 v93, v6, v5

    s_add_u32 s33, s32, 4
    s_lshr_b32 s34, s33, 2
    s_lshl_b32 s34, s34, 13
    s_and_b32 s33, s33, 3
    v_xor_b32 v6, s33, v4
    v_lshlrev_b32 v6, 5, v6
    v_add_u32 v6, s34, v6
    v_add_u32 v94, v6, v5

    s_add_u32 s33, s32, 5
    s_lshr_b32 s34, s33, 2
    s_lshl_b32 s34, s34, 13
    s_and_b32 s33, s33, 3
    v_xor_b32 v6, s33, v4
    v_lshlrev_b32 v6, 5, v6
    v_add_u32 v6, s34, v6
    v_add_u32 v95, v6, v5

    v_mov_b32 v3, 0
    v_mov_b32 v4, 0
    s_and_b32 s34, s2, 6
    s_lshl_b32 s34, s34, 4
    s_lshr_b32 s35, s2, 3
    s_add_u32 s34, s34, s35
    s_lshl_b32 s34, s34, 3
    s_and_b32 s35, s2, 1
    s_lshl_b32 s35, s35, 10
    s_add_u32 s34, s34, s35
    s_lshr_b32 s38, s34, 7
    s_lshl_b32 s38, s38, 2
    s_lshl_b32 s35, s26, 1
    s_add_u32 s34, s34, s35
    v_lshrrev_b32 v1, 5, v0
    v_add_u32 v1, s34, v1
    v_lshlrev_b32 v3, 3, v1
    v_lshlrev_b32 v1, 11, v1
    v_and_b32 v2, 31, v0
    v_lshl_add_u32 v1, v2, 4, v1

    buffer_load_dwordx4 v[196:199], v1, s[4:7], 0 offen offset:0
    buffer_load_dwordx4 v[200:203], v1, s[4:7], 0 offen offset:512
    buffer_load_dwordx4 v[204:207], v1, s[4:7], 0 offen offset:1024
    buffer_load_dwordx4 v[208:211], v1, s[4:7], 0 offen offset:1536
    s_and_b32 s34, s2, 1
    s_lshl_b32 s34, s34, 5
    s_lshr_b32 s35, s2, 3
    s_add_u32 s34, s34, s35
    s_and_b32 s35, s34, 3
    s_lshr_b32 s34, s34, 2
    s_and_b32 s36, s2, 6
    s_lshl_b32 s36, s36, 1
    s_add_u32 s35, s35, s36
    s_lshl_b32 s39, s35, 2
    s_add_u32 s39, s39, 64
    s_lshl_b32 s36, s34, 6
    v_lshrrev_b32 v1, 3, v0
    v_add_u32 v1, s36, v1
    s_mov_b32 s36, 6144
    v_mul_lo_u32 v1, v1, s36
    v_and_b32 v2, 7, v0
    v_min_u32 v2, 5, v2
    v_lshl_add_u32 v1, v2, 4, v1
    s_mul_i32 s36, s35, 384
    s_mul_i32 s37, s26, 96
    s_add_u32 s36, s36, s37
    v_add_u32 v1, s36, v1
    s_mul_i32 s34, s34, 12288
    s_lshl_b32 s36, s36, 1
    s_add_u32 s34, s34, s36
    v_lshlrev_b32 v4, 5, v0
    v_add_u32 v4, s34, v4

    s_mov_b32 s36, 0
    buffer_load_dwordx4 v[212:215], v1, s[8:11], s36 offen
    s_mov_b32 s36, 49152
    buffer_load_dwordx4 v[216:219], v1, s[8:11], s36 offen
    s_mov_b32 s36, 98304
    buffer_load_dwordx4 v[220:223], v1, s[8:11], s36 offen
    s_mov_b32 s36, 147456
    buffer_load_dwordx4 v[224:227], v1, s[8:11], s36 offen
    s_mov_b32 s36, 196608
    buffer_load_dwordx4 v[228:231], v1, s[8:11], s36 offen
    s_mov_b32 s36, 245760
    buffer_load_dwordx4 v[232:235], v1, s[8:11], s36 offen
    s_mov_b32 s36, 294912
    buffer_load_dwordx4 v[236:239], v1, s[8:11], s36 offen
    s_mov_b32 s36, 344064
    buffer_load_dwordx4 v[240:243], v1, s[8:11], s36 offen
    v_mov_b32 v96, 0
    v_mov_b32 v97, 0
    v_mov_b32 v98, 0
    v_mov_b32 v99, 0
    v_mov_b32 v100, 0
    v_mov_b32 v101, 0
    v_mov_b32 v102, 0
    v_mov_b32 v103, 0
    v_mov_b32 v104, 0
    v_mov_b32 v105, 0
    v_mov_b32 v106, 0
    v_mov_b32 v107, 0
    v_mov_b32 v108, 0
    v_mov_b32 v109, 0
    v_mov_b32 v110, 0
    v_mov_b32 v111, 0
    v_mov_b32 v112, 0
    v_mov_b32 v113, 0
    v_mov_b32 v114, 0
    v_mov_b32 v115, 0
    v_mov_b32 v116, 0
    v_mov_b32 v117, 0
    v_mov_b32 v118, 0
    v_mov_b32 v119, 0
    v_mov_b32 v120, 0
    v_mov_b32 v121, 0
    v_mov_b32 v122, 0
    v_mov_b32 v123, 0
    v_mov_b32 v124, 0
    v_mov_b32 v125, 0
    v_mov_b32 v126, 0
    v_mov_b32 v127, 0
    v_mov_b32 v128, 0
    v_mov_b32 v129, 0
    v_mov_b32 v130, 0
    v_mov_b32 v131, 0
    v_mov_b32 v132, 0
    v_mov_b32 v133, 0
    v_mov_b32 v134, 0
    v_mov_b32 v135, 0
    v_mov_b32 v136, 0
    v_mov_b32 v137, 0
    v_mov_b32 v138, 0
    v_mov_b32 v139, 0
    v_mov_b32 v140, 0
    v_mov_b32 v141, 0
    v_mov_b32 v142, 0
    v_mov_b32 v143, 0
    v_mov_b32 v144, 0
    v_mov_b32 v145, 0
    v_mov_b32 v146, 0
    v_mov_b32 v147, 0
    v_mov_b32 v148, 0
    v_mov_b32 v149, 0
    v_mov_b32 v150, 0
    v_mov_b32 v151, 0
    v_mov_b32 v152, 0
    v_mov_b32 v153, 0
    v_mov_b32 v154, 0
    v_mov_b32 v155, 0
    v_mov_b32 v156, 0
    v_mov_b32 v157, 0
    v_mov_b32 v158, 0
    v_mov_b32 v159, 0
    v_mov_b32 v160, 0
    v_mov_b32 v161, 0
    v_mov_b32 v162, 0
    v_mov_b32 v163, 0
    v_mov_b32 v164, 0
    v_mov_b32 v165, 0
    v_mov_b32 v166, 0
    v_mov_b32 v167, 0
    v_mov_b32 v168, 0
    v_mov_b32 v169, 0
    v_mov_b32 v170, 0
    v_mov_b32 v171, 0
    v_mov_b32 v172, 0
    v_mov_b32 v173, 0
    v_mov_b32 v174, 0
    v_mov_b32 v175, 0
    v_mov_b32 v176, 0
    v_mov_b32 v177, 0
    v_mov_b32 v178, 0
    v_mov_b32 v179, 0
    v_mov_b32 v180, 0
    v_mov_b32 v181, 0
    v_mov_b32 v182, 0
    v_mov_b32 v183, 0
    v_mov_b32 v184, 0
    v_mov_b32 v185, 0
    v_mov_b32 v186, 0
    v_mov_b32 v187, 0
    v_mov_b32 v188, 0
    v_mov_b32 v189, 0
    v_mov_b32 v190, 0
    v_mov_b32 v191, 0
    s_waitcnt vmcnt(0)
    v_mov_b32 v244, 0
    v_mov_b32 v245, 0
    v_mov_b32 v246, 0
    v_mov_b32 v247, 0
    v_lshlrev_b32 v248, 16, v196
    v_and_b32 v249, 0xffff0000, v196
    v_add_f32 v244, v244, v248
    v_add_f32 v245, v245, v249
    v_fmac_f32 v246, v248, v248
    v_fmac_f32 v247, v249, v249
    v_lshlrev_b32 v250, 16, v197
    v_and_b32 v251, 0xffff0000, v197
    v_add_f32 v244, v244, v250
    v_add_f32 v245, v245, v251
    v_fmac_f32 v246, v250, v250
    v_fmac_f32 v247, v251, v251
    v_lshlrev_b32 v248, 16, v198
    v_and_b32 v249, 0xffff0000, v198
    v_add_f32 v244, v244, v248
    v_add_f32 v245, v245, v249
    v_fmac_f32 v246, v248, v248
    v_fmac_f32 v247, v249, v249
    v_lshlrev_b32 v250, 16, v199
    v_and_b32 v251, 0xffff0000, v199
    v_add_f32 v244, v244, v250
    v_add_f32 v245, v245, v251
    v_fmac_f32 v246, v250, v250
    v_fmac_f32 v247, v251, v251
    v_lshlrev_b32 v248, 16, v200
    v_and_b32 v249, 0xffff0000, v200
    v_add_f32 v244, v244, v248
    v_add_f32 v245, v245, v249
    v_fmac_f32 v246, v248, v248
    v_fmac_f32 v247, v249, v249
    v_lshlrev_b32 v250, 16, v201
    v_and_b32 v251, 0xffff0000, v201
    v_add_f32 v244, v244, v250
    v_add_f32 v245, v245, v251
    v_fmac_f32 v246, v250, v250
    v_fmac_f32 v247, v251, v251
    v_lshlrev_b32 v248, 16, v202
    v_and_b32 v249, 0xffff0000, v202
    v_add_f32 v244, v244, v248
    v_add_f32 v245, v245, v249
    v_fmac_f32 v246, v248, v248
    v_fmac_f32 v247, v249, v249
    v_lshlrev_b32 v250, 16, v203
    v_and_b32 v251, 0xffff0000, v203
    v_add_f32 v244, v244, v250
    v_add_f32 v245, v245, v251
    v_fmac_f32 v246, v250, v250
    v_fmac_f32 v247, v251, v251
    v_lshlrev_b32 v248, 16, v204
    v_and_b32 v249, 0xffff0000, v204
    v_add_f32 v244, v244, v248
    v_add_f32 v245, v245, v249
    v_fmac_f32 v246, v248, v248
    v_fmac_f32 v247, v249, v249
    v_lshlrev_b32 v250, 16, v205
    v_and_b32 v251, 0xffff0000, v205
    v_add_f32 v244, v244, v250
    v_add_f32 v245, v245, v251
    v_fmac_f32 v246, v250, v250
    v_fmac_f32 v247, v251, v251
    v_lshlrev_b32 v248, 16, v206
    v_and_b32 v249, 0xffff0000, v206
    v_add_f32 v244, v244, v248
    v_add_f32 v245, v245, v249
    v_fmac_f32 v246, v248, v248
    v_fmac_f32 v247, v249, v249
    v_lshlrev_b32 v250, 16, v207
    v_and_b32 v251, 0xffff0000, v207
    v_add_f32 v244, v244, v250
    v_add_f32 v245, v245, v251
    v_fmac_f32 v246, v250, v250
    v_fmac_f32 v247, v251, v251
    v_lshlrev_b32 v248, 16, v208
    v_and_b32 v249, 0xffff0000, v208
    v_add_f32 v244, v244, v248
    v_add_f32 v245, v245, v249
    v_fmac_f32 v246, v248, v248
    v_fmac_f32 v247, v249, v249
    v_lshlrev_b32 v250, 16, v209
    v_and_b32 v251, 0xffff0000, v209
    v_add_f32 v244, v244, v250
    v_add_f32 v245, v245, v251
    v_fmac_f32 v246, v250, v250
    v_fmac_f32 v247, v251, v251
    v_lshlrev_b32 v248, 16, v210
    v_and_b32 v249, 0xffff0000, v210
    v_add_f32 v244, v244, v248
    v_add_f32 v245, v245, v249
    v_fmac_f32 v246, v248, v248
    v_fmac_f32 v247, v249, v249
    v_lshlrev_b32 v250, 16, v211
    v_and_b32 v251, 0xffff0000, v211
    v_add_f32 v244, v244, v250
    v_add_f32 v245, v245, v251
    v_fmac_f32 v246, v250, v250
    v_fmac_f32 v247, v251, v251
    v_add_f32 v244, v244, v245
    v_add_f32 v246, v246, v247
    s_nop 1
    v_add_f32_dpp v244, v244, v244 row_ror:8 row_mask:0xf bank_mask:0xf
    v_add_f32_dpp v246, v246, v246 row_ror:8 row_mask:0xf bank_mask:0xf
    s_nop 1
    v_add_f32_dpp v244, v244, v244 row_ror:4 row_mask:0xf bank_mask:0xf
    v_add_f32_dpp v246, v246, v246 row_ror:4 row_mask:0xf bank_mask:0xf
    s_nop 1
    v_add_f32_dpp v244, v244, v244 row_ror:2 row_mask:0xf bank_mask:0xf
    v_add_f32_dpp v246, v246, v246 row_ror:2 row_mask:0xf bank_mask:0xf
    s_nop 1
    v_add_f32_dpp v244, v244, v244 row_ror:1 row_mask:0xf bank_mask:0xf
    v_add_f32_dpp v246, v246, v246 row_ror:1 row_mask:0xf bank_mask:0xf
    v_mov_b32 v245, v244
    v_mov_b32 v247, v246
    s_nop 1
    v_permlane16_swap_b32 v244, v245
    v_permlane16_swap_b32 v246, v247
    s_nop 1
    v_add_f32 v244, v244, v245
    v_add_f32 v246, v246, v247
    v_mul_f32 v244, 0x3a800000, v244
    v_mul_f32 v246, 0x3a800000, v246
    v_fma_f32 v246, -v244, v244, v246
    v_max_f32 v246, 0, v246
    v_add_f32 v246, 0x3727c5ac, v246
    v_sqrt_f32 v246, v246
    s_nop 0
    v_rcp_f32 v245, v246

    v_lshlrev_b32 v248, 16, v212
    v_and_b32 v249, 0xffff0000, v212
    v_lshlrev_b32 v250, 16, v213
    v_and_b32 v251, 0xffff0000, v213
    v_lshlrev_b32 v252, 16, v214
    v_and_b32 v253, 0xffff0000, v214
    v_lshlrev_b32 v254, 16, v215
    v_and_b32 v255, 0xffff0000, v215
    s_mov_b32 exec_lo, 1
    s_mov_b32 exec_hi, 1
    buffer_store_dwordx2 v[244:245], v3, s[44:47], 0 offen sc1
    s_mov_b64 exec, -1
    v_lshlrev_b32 v196, 16, v216
    v_and_b32 v197, 0xffff0000, v216
    v_lshlrev_b32 v198, 16, v217
    v_and_b32 v199, 0xffff0000, v217
    v_lshlrev_b32 v200, 16, v218
    v_and_b32 v201, 0xffff0000, v218
    v_lshlrev_b32 v202, 16, v219
    v_and_b32 v203, 0xffff0000, v219
    v_add_f32 v248, v248, v196
    v_add_f32 v249, v249, v197
    v_add_f32 v250, v250, v198
    v_add_f32 v251, v251, v199
    v_add_f32 v252, v252, v200
    v_add_f32 v253, v253, v201
    v_add_f32 v254, v254, v202
    v_add_f32 v255, v255, v203
    v_lshlrev_b32 v196, 16, v220
    v_and_b32 v197, 0xffff0000, v220
    v_lshlrev_b32 v198, 16, v221
    v_and_b32 v199, 0xffff0000, v221
    v_lshlrev_b32 v200, 16, v222
    v_and_b32 v201, 0xffff0000, v222
    v_lshlrev_b32 v202, 16, v223
    v_and_b32 v203, 0xffff0000, v223
    v_add_f32 v248, v248, v196
    v_add_f32 v249, v249, v197
    v_add_f32 v250, v250, v198
    v_add_f32 v251, v251, v199
    v_add_f32 v252, v252, v200
    v_add_f32 v253, v253, v201
    v_add_f32 v254, v254, v202
    v_add_f32 v255, v255, v203
    v_lshlrev_b32 v196, 16, v224
    v_and_b32 v197, 0xffff0000, v224
    v_lshlrev_b32 v198, 16, v225
    v_and_b32 v199, 0xffff0000, v225
    v_lshlrev_b32 v200, 16, v226
    v_and_b32 v201, 0xffff0000, v226
    v_lshlrev_b32 v202, 16, v227
    v_and_b32 v203, 0xffff0000, v227
    v_add_f32 v248, v248, v196
    v_add_f32 v249, v249, v197
    v_add_f32 v250, v250, v198
    v_add_f32 v251, v251, v199
    v_add_f32 v252, v252, v200
    v_add_f32 v253, v253, v201
    v_add_f32 v254, v254, v202
    v_add_f32 v255, v255, v203
    v_lshlrev_b32 v196, 16, v228
    v_and_b32 v197, 0xffff0000, v228
    v_lshlrev_b32 v198, 16, v229
    v_and_b32 v199, 0xffff0000, v229
    v_lshlrev_b32 v200, 16, v230
    v_and_b32 v201, 0xffff0000, v230
    v_lshlrev_b32 v202, 16, v231
    v_and_b32 v203, 0xffff0000, v231
    v_add_f32 v248, v248, v196
    v_add_f32 v249, v249, v197
    v_add_f32 v250, v250, v198
    v_add_f32 v251, v251, v199
    v_add_f32 v252, v252, v200
    v_add_f32 v253, v253, v201
    v_add_f32 v254, v254, v202
    v_add_f32 v255, v255, v203
    v_lshlrev_b32 v196, 16, v232
    v_and_b32 v197, 0xffff0000, v232
    v_lshlrev_b32 v198, 16, v233
    v_and_b32 v199, 0xffff0000, v233
    v_lshlrev_b32 v200, 16, v234
    v_and_b32 v201, 0xffff0000, v234
    v_lshlrev_b32 v202, 16, v235
    v_and_b32 v203, 0xffff0000, v235
    v_add_f32 v248, v248, v196
    v_add_f32 v249, v249, v197
    v_add_f32 v250, v250, v198
    v_add_f32 v251, v251, v199
    v_add_f32 v252, v252, v200
    v_add_f32 v253, v253, v201
    v_add_f32 v254, v254, v202
    v_add_f32 v255, v255, v203
    v_lshlrev_b32 v196, 16, v236
    v_and_b32 v197, 0xffff0000, v236
    v_lshlrev_b32 v198, 16, v237
    v_and_b32 v199, 0xffff0000, v237
    v_lshlrev_b32 v200, 16, v238
    v_and_b32 v201, 0xffff0000, v238
    v_lshlrev_b32 v202, 16, v239
    v_and_b32 v203, 0xffff0000, v239
    v_add_f32 v248, v248, v196
    v_add_f32 v249, v249, v197
    v_add_f32 v250, v250, v198
    v_add_f32 v251, v251, v199
    v_add_f32 v252, v252, v200
    v_add_f32 v253, v253, v201
    v_add_f32 v254, v254, v202
    v_add_f32 v255, v255, v203
    v_lshlrev_b32 v196, 16, v240
    v_and_b32 v197, 0xffff0000, v240
    v_lshlrev_b32 v198, 16, v241
    v_and_b32 v199, 0xffff0000, v241
    v_lshlrev_b32 v200, 16, v242
    v_and_b32 v201, 0xffff0000, v242
    v_lshlrev_b32 v202, 16, v243
    v_and_b32 v203, 0xffff0000, v243
    v_add_f32 v248, v248, v196
    v_add_f32 v249, v249, v197
    v_add_f32 v250, v250, v198
    v_add_f32 v251, v251, v199
    v_add_f32 v252, v252, v200
    v_add_f32 v253, v253, v201
    v_add_f32 v254, v254, v202
    v_add_f32 v255, v255, v203
    s_nop 1
    v_add_f32_dpp v248, v248, v248 row_ror:8 row_mask:0xf bank_mask:0xf
    v_add_f32_dpp v249, v249, v249 row_ror:8 row_mask:0xf bank_mask:0xf
    v_add_f32_dpp v250, v250, v250 row_ror:8 row_mask:0xf bank_mask:0xf
    v_add_f32_dpp v251, v251, v251 row_ror:8 row_mask:0xf bank_mask:0xf
    v_add_f32_dpp v252, v252, v252 row_ror:8 row_mask:0xf bank_mask:0xf
    v_add_f32_dpp v253, v253, v253 row_ror:8 row_mask:0xf bank_mask:0xf
    v_add_f32_dpp v254, v254, v254 row_ror:8 row_mask:0xf bank_mask:0xf
    v_add_f32_dpp v255, v255, v255 row_ror:8 row_mask:0xf bank_mask:0xf
    v_mov_b32 v196, v248
    v_mov_b32 v197, v249
    v_mov_b32 v198, v250
    v_mov_b32 v199, v251
    v_mov_b32 v200, v252
    v_mov_b32 v201, v253
    v_mov_b32 v202, v254
    v_mov_b32 v203, v255
    s_nop 1
    v_permlane16_swap_b32 v248, v196
    v_permlane16_swap_b32 v249, v197
    v_permlane16_swap_b32 v250, v198
    v_permlane16_swap_b32 v251, v199
    v_permlane16_swap_b32 v252, v200
    v_permlane16_swap_b32 v253, v201
    v_permlane16_swap_b32 v254, v202
    v_permlane16_swap_b32 v255, v203
    s_nop 1
    v_add_f32 v248, v248, v196
    v_add_f32 v249, v249, v197
    v_add_f32 v250, v250, v198
    v_add_f32 v251, v251, v199
    v_add_f32 v252, v252, v200
    v_add_f32 v253, v253, v201
    v_add_f32 v254, v254, v202
    v_add_f32 v255, v255, v203
    v_mov_b32 v196, v248
    v_mov_b32 v197, v249
    v_mov_b32 v198, v250
    v_mov_b32 v199, v251
    v_mov_b32 v200, v252
    v_mov_b32 v201, v253
    v_mov_b32 v202, v254
    v_mov_b32 v203, v255
    s_nop 1
    v_permlane32_swap_b32 v248, v196
    v_permlane32_swap_b32 v249, v197
    v_permlane32_swap_b32 v250, v198
    v_permlane32_swap_b32 v251, v199
    v_permlane32_swap_b32 v252, v200
    v_permlane32_swap_b32 v253, v201
    v_permlane32_swap_b32 v254, v202
    v_permlane32_swap_b32 v255, v203
    s_nop 1
    v_add_f32 v248, v248, v196
    v_add_f32 v249, v249, v197
    v_add_f32 v250, v250, v198
    v_add_f32 v251, v251, v199
    v_add_f32 v252, v252, v200
    v_add_f32 v253, v253, v201
    v_add_f32 v254, v254, v202
    v_add_f32 v255, v255, v203
    s_mov_b64 exec, 0x3f
    buffer_store_dwordx4 v[248:251], v4, s[48:51], 0 offen sc1
    buffer_store_dwordx4 v[252:255], v4, s[48:51], 0 offen offset:16 sc1
    s_mov_b64 exec, -1
    s_barrier
    ds_read_b128 v[8:11], v88 offset:0
    ds_read_b128 v[12:15], v88 offset:2048
    ds_read_b128 v[16:19], v88 offset:4096
    ds_read_b128 v[20:23], v88 offset:6144
    ds_read_b64_tr_b16 v[40:41], v90 offset:0
    ds_read_b64_tr_b16 v[42:43], v90 offset:512
    ds_read_b64_tr_b16 v[44:45], v91 offset:0
    ds_read_b64_tr_b16 v[46:47], v91 offset:512
    ds_read_b64_tr_b16 v[48:49], v92 offset:0
    ds_read_b64_tr_b16 v[50:51], v92 offset:512
    ds_read_b64_tr_b16 v[52:53], v93 offset:0
    ds_read_b64_tr_b16 v[54:55], v93 offset:512
    ds_read_b64_tr_b16 v[56:57], v94 offset:0
    ds_read_b64_tr_b16 v[58:59], v94 offset:512
    ds_read_b64_tr_b16 v[60:61], v95 offset:0
    ds_read_b64_tr_b16 v[62:63], v95 offset:512
    s_mov_b32 s28, 0
    s_mov_b32 s29, 0
qkv_kernel_cloop:
    s_waitcnt lgkmcnt(0)
    v_mfma_f32_16x16x32_bf16 v[96:99], v[40:43], v[8:11], v[96:99]
    ds_read_b128 v[24:27], v89 offset:0
    v_mfma_f32_16x16x32_bf16 v[100:103], v[40:43], v[12:15], v[100:103]
    ds_read_b128 v[28:31], v89 offset:2048
    v_mfma_f32_16x16x32_bf16 v[104:107], v[40:43], v[16:19], v[104:107]
    ds_read_b128 v[32:35], v89 offset:4096
    v_mfma_f32_16x16x32_bf16 v[108:111], v[40:43], v[20:23], v[108:111]
    ds_read_b128 v[36:39], v89 offset:6144
    v_mfma_f32_16x16x32_bf16 v[112:115], v[44:47], v[8:11], v[112:115]
    ds_read_b64_tr_b16 v[64:65], v90 offset:4096
    v_mfma_f32_16x16x32_bf16 v[116:119], v[44:47], v[12:15], v[116:119]
    ds_read_b64_tr_b16 v[66:67], v90 offset:4608
    v_mfma_f32_16x16x32_bf16 v[120:123], v[44:47], v[16:19], v[120:123]
    ds_read_b64_tr_b16 v[68:69], v91 offset:4096
    v_mfma_f32_16x16x32_bf16 v[124:127], v[44:47], v[20:23], v[124:127]
    ds_read_b64_tr_b16 v[70:71], v91 offset:4608
    v_mfma_f32_16x16x32_bf16 v[128:131], v[48:51], v[8:11], v[128:131]
    ds_read_b64_tr_b16 v[72:73], v92 offset:4096
    v_mfma_f32_16x16x32_bf16 v[132:135], v[48:51], v[12:15], v[132:135]
    ds_read_b64_tr_b16 v[74:75], v92 offset:4608
    v_mfma_f32_16x16x32_bf16 v[136:139], v[48:51], v[16:19], v[136:139]
    ds_read_b64_tr_b16 v[76:77], v93 offset:4096
    v_mfma_f32_16x16x32_bf16 v[140:143], v[48:51], v[20:23], v[140:143]
    ds_read_b64_tr_b16 v[78:79], v93 offset:4608
    v_mfma_f32_16x16x32_bf16 v[144:147], v[52:55], v[8:11], v[144:147]
    ds_read_b64_tr_b16 v[80:81], v94 offset:4096
    v_mfma_f32_16x16x32_bf16 v[148:151], v[52:55], v[12:15], v[148:151]
    ds_read_b64_tr_b16 v[82:83], v94 offset:4608
    v_mfma_f32_16x16x32_bf16 v[152:155], v[52:55], v[16:19], v[152:155]
    ds_read_b64_tr_b16 v[84:85], v95 offset:4096
    v_mfma_f32_16x16x32_bf16 v[156:159], v[52:55], v[20:23], v[156:159]
    ds_read_b64_tr_b16 v[86:87], v95 offset:4608
    v_mfma_f32_16x16x32_bf16 v[160:163], v[56:59], v[8:11], v[160:163]
    s_add_u32 s29, s29, 1
    s_cmp_eq_u32 s29, 4
    v_mfma_f32_16x16x32_bf16 v[164:167], v[56:59], v[12:15], v[164:167]
    s_cselect_b32 s27, 4294844416, s40
    s_cselect_b32 s29, 0, s29
    v_mfma_f32_16x16x32_bf16 v[168:171], v[56:59], v[16:19], v[168:171]
    s_add_u32 s28, s28, 1
    v_add_u32 v88, s27, v88
    v_mfma_f32_16x16x32_bf16 v[172:175], v[56:59], v[20:23], v[172:175]
    v_add_u32 v89, s27, v89
    v_add_u32 v90, s27, v90
    v_mfma_f32_16x16x32_bf16 v[176:179], v[60:63], v[8:11], v[176:179]
    v_add_u32 v91, s27, v91
    v_add_u32 v92, s27, v92
    v_mfma_f32_16x16x32_bf16 v[180:183], v[60:63], v[12:15], v[180:183]
    v_add_u32 v93, s27, v93
    v_add_u32 v94, s27, v94
    v_mfma_f32_16x16x32_bf16 v[184:187], v[60:63], v[16:19], v[184:187]
    v_add_u32 v95, s27, v95
    v_mfma_f32_16x16x32_bf16 v[188:191], v[60:63], v[20:23], v[188:191]
    s_waitcnt lgkmcnt(0)
    s_cmp_eq_u32 s28, 16
    s_cbranch_scc1 qkv_kernel_clast
    s_barrier

    s_sub_u32 s32, s28, 2
    s_cmp_lt_u32 s32, 2
    s_cbranch_scc1 qkv_kernel_arr
qkv_kernel_arrdone:
    v_mfma_f32_16x16x32_bf16 v[96:99], v[64:67], v[24:27], v[96:99]
    ds_read_b128 v[8:11], v88 offset:0
    v_mfma_f32_16x16x32_bf16 v[100:103], v[64:67], v[28:31], v[100:103]
    ds_read_b128 v[12:15], v88 offset:2048
    v_mfma_f32_16x16x32_bf16 v[104:107], v[64:67], v[32:35], v[104:107]
    ds_read_b128 v[16:19], v88 offset:4096
    v_mfma_f32_16x16x32_bf16 v[108:111], v[64:67], v[36:39], v[108:111]
    ds_read_b128 v[20:23], v88 offset:6144
    v_mfma_f32_16x16x32_bf16 v[112:115], v[68:71], v[24:27], v[112:115]
    ds_read_b64_tr_b16 v[40:41], v90 offset:0
    v_mfma_f32_16x16x32_bf16 v[116:119], v[68:71], v[28:31], v[116:119]
    ds_read_b64_tr_b16 v[42:43], v90 offset:512
    v_mfma_f32_16x16x32_bf16 v[120:123], v[68:71], v[32:35], v[120:123]
    ds_read_b64_tr_b16 v[44:45], v91 offset:0
    v_mfma_f32_16x16x32_bf16 v[124:127], v[68:71], v[36:39], v[124:127]
    ds_read_b64_tr_b16 v[46:47], v91 offset:512
    v_mfma_f32_16x16x32_bf16 v[128:131], v[72:75], v[24:27], v[128:131]
    ds_read_b64_tr_b16 v[48:49], v92 offset:0
    v_mfma_f32_16x16x32_bf16 v[132:135], v[72:75], v[28:31], v[132:135]
    ds_read_b64_tr_b16 v[50:51], v92 offset:512
    v_mfma_f32_16x16x32_bf16 v[136:139], v[72:75], v[32:35], v[136:139]
    ds_read_b64_tr_b16 v[52:53], v93 offset:0
    v_mfma_f32_16x16x32_bf16 v[140:143], v[72:75], v[36:39], v[140:143]
    ds_read_b64_tr_b16 v[54:55], v93 offset:512
    v_mfma_f32_16x16x32_bf16 v[144:147], v[76:79], v[24:27], v[144:147]
    ds_read_b64_tr_b16 v[56:57], v94 offset:0
    v_mfma_f32_16x16x32_bf16 v[148:151], v[76:79], v[28:31], v[148:151]
    ds_read_b64_tr_b16 v[58:59], v94 offset:512
    v_mfma_f32_16x16x32_bf16 v[152:155], v[76:79], v[32:35], v[152:155]
    ds_read_b64_tr_b16 v[60:61], v95 offset:0
    v_mfma_f32_16x16x32_bf16 v[156:159], v[76:79], v[36:39], v[156:159]
    ds_read_b64_tr_b16 v[62:63], v95 offset:512
    v_mfma_f32_16x16x32_bf16 v[160:163], v[80:83], v[24:27], v[160:163]
    v_mfma_f32_16x16x32_bf16 v[164:167], v[80:83], v[28:31], v[164:167]
    v_mfma_f32_16x16x32_bf16 v[168:171], v[80:83], v[32:35], v[168:171]
    v_mfma_f32_16x16x32_bf16 v[172:175], v[80:83], v[36:39], v[172:175]
    v_mfma_f32_16x16x32_bf16 v[176:179], v[84:87], v[24:27], v[176:179]
    v_mfma_f32_16x16x32_bf16 v[180:183], v[84:87], v[28:31], v[180:183]
    v_mfma_f32_16x16x32_bf16 v[184:187], v[84:87], v[32:35], v[184:187]
    v_mfma_f32_16x16x32_bf16 v[188:191], v[84:87], v[36:39], v[188:191]
    s_branch qkv_kernel_cloop
qkv_kernel_arr:
    s_waitcnt vmcnt(0)
    s_cmp_eq_u32 s32, 0
    s_cbranch_scc1 qkv_kernel_arrdone
    s_cmp_lg_u32 s26, 0
    s_cbranch_scc1 qkv_kernel_arrdone
    v_mov_b32 v1, 0
    v_mov_b32 v2, 1

    s_mov_b64 exec, 1
    buffer_atomic_add v2, v1, s[56:59], 0 offen sc1
    s_mov_b64 exec, -1
    s_branch qkv_kernel_arrdone

qkv_kernel_clast:
    v_mfma_f32_16x16x32_bf16 v[96:99], v[64:67], v[24:27], v[96:99]
    v_mfma_f32_16x16x32_bf16 v[100:103], v[64:67], v[28:31], v[100:103]
    v_mfma_f32_16x16x32_bf16 v[104:107], v[64:67], v[32:35], v[104:107]
    v_mfma_f32_16x16x32_bf16 v[108:111], v[64:67], v[36:39], v[108:111]
    v_mfma_f32_16x16x32_bf16 v[112:115], v[68:71], v[24:27], v[112:115]
    v_mfma_f32_16x16x32_bf16 v[116:119], v[68:71], v[28:31], v[116:119]
    v_mfma_f32_16x16x32_bf16 v[120:123], v[68:71], v[32:35], v[120:123]
    v_mfma_f32_16x16x32_bf16 v[124:127], v[68:71], v[36:39], v[124:127]
    v_mfma_f32_16x16x32_bf16 v[128:131], v[72:75], v[24:27], v[128:131]
    v_mfma_f32_16x16x32_bf16 v[132:135], v[72:75], v[28:31], v[132:135]
    v_mfma_f32_16x16x32_bf16 v[136:139], v[72:75], v[32:35], v[136:139]
    v_mfma_f32_16x16x32_bf16 v[140:143], v[72:75], v[36:39], v[140:143]
    v_mfma_f32_16x16x32_bf16 v[144:147], v[76:79], v[24:27], v[144:147]
    v_mfma_f32_16x16x32_bf16 v[148:151], v[76:79], v[28:31], v[148:151]
    v_mfma_f32_16x16x32_bf16 v[152:155], v[76:79], v[32:35], v[152:155]
    v_mfma_f32_16x16x32_bf16 v[156:159], v[76:79], v[36:39], v[156:159]
    v_mfma_f32_16x16x32_bf16 v[160:163], v[80:83], v[24:27], v[160:163]
    v_mfma_f32_16x16x32_bf16 v[164:167], v[80:83], v[28:31], v[164:167]
    v_mfma_f32_16x16x32_bf16 v[168:171], v[80:83], v[32:35], v[168:171]
    v_mfma_f32_16x16x32_bf16 v[172:175], v[80:83], v[36:39], v[172:175]
    v_mfma_f32_16x16x32_bf16 v[176:179], v[84:87], v[24:27], v[176:179]
    v_mfma_f32_16x16x32_bf16 v[180:183], v[84:87], v[28:31], v[180:183]
    v_mfma_f32_16x16x32_bf16 v[184:187], v[84:87], v[32:35], v[184:187]
    v_mfma_f32_16x16x32_bf16 v[188:191], v[84:87], v[36:39], v[188:191]
    v_and_b32 v1, 15, v0
    v_lshrrev_b32 v2, 4, v0
    s_lshl_b32 s32, s30, 6
    v_add_u32 v1, s32, v1
    s_mov_b32 s33, 784
    v_mul_lo_u32 v1, v1, s33
    s_mul_i32 s34, s31, 384
    v_lshlrev_b32 v2, 4, v2
    v_add3_u32 v1, v1, v2, s34

    s_barrier
    ds_write_b128 v1, v[96:99] offset:0
    ds_write_b128 v1, v[112:115] offset:64
    ds_write_b128 v1, v[128:131] offset:128
    ds_write_b128 v1, v[144:147] offset:192
    ds_write_b128 v1, v[160:163] offset:256
    ds_write_b128 v1, v[176:179] offset:320
    ds_write_b128 v1, v[100:103] offset:12544
    ds_write_b128 v1, v[116:119] offset:12608
    ds_write_b128 v1, v[132:135] offset:12672
    ds_write_b128 v1, v[148:151] offset:12736
    ds_write_b128 v1, v[164:167] offset:12800
    ds_write_b128 v1, v[180:183] offset:12864
    ds_write_b128 v1, v[104:107] offset:25088
    ds_write_b128 v1, v[120:123] offset:25152
    ds_write_b128 v1, v[136:139] offset:25216
    ds_write_b128 v1, v[152:155] offset:25280
    ds_write_b128 v1, v[168:171] offset:25344
    ds_write_b128 v1, v[184:187] offset:25408
    ds_write_b128 v1, v[108:111] offset:37632
    ds_write_b128 v1, v[124:127] offset:37696
    ds_write_b128 v1, v[140:143] offset:37760
    ds_write_b128 v1, v[156:159] offset:37824
    ds_write_b128 v1, v[172:175] offset:37888
    ds_write_b128 v1, v[188:191] offset:37952
    s_waitcnt lgkmcnt(0)
    s_branch qkv_kernel_epi2
qkv_kernel_prod:
    v_mov_b32 v51, v5
    s_sub_u32 s27, s26, 4
    v_lshrrev_b32 v1, 3, v0
    v_and_b32 v2, 7, v0
    v_lshrrev_b32 v3, 4, v0
    s_and_b32 s34, s27, 1
    s_lshl_b32 s35, s34, 2

    v_xor_b32 v4, v2, v3
    v_xor_b32 v4, s35, v4
    s_lshl_b32 s36, s27, 3
    s_add_u32 s37, s36, s24
    v_add_u32 v5, s37, v1
    s_mov_b32 s38, 2048
    v_mul_lo_u32 v5, v5, s38
    v_lshl_add_u32 v48, v4, 4, v5

    v_and_b32 v4, 1, v3
    s_lshl_b32 s35, s34, 1
    v_or_b32 v4, s35, v4
    v_lshlrev_b32 v4, 1, v4
    v_xor_b32 v4, v4, v2
    v_add_u32 v5, s36, v1
    s_mov_b32 s38, 6144
    v_mul_lo_u32 v5, v5, s38
    s_lshl_b32 s39, s25, 1

    v_add_u32 v5, s39, v5
    v_lshl_add_u32 v49, v4, 4, v5

    s_mul_i32 s28, s41, 2048
    s_mul_i32 s29, s41, 6291456
    s_lshl_b32 s30, s27, 10
    s_mov_b32 s33, 0

    s_add_u32 m0, s30, 0
    s_add_u32 s31, s28, 0
    buffer_load_dwordx4 v48, s[4:7], s31 offen lds
    s_add_u32 m0, s30, 4096
    s_add_u32 s31, s28, 65536
    buffer_load_dwordx4 v48, s[4:7], s31 offen lds
    s_add_u32 m0, s30, 8192
    s_add_u32 s31, s28, 131072
    buffer_load_dwordx4 v48, s[4:7], s31 offen lds
    s_add_u32 m0, s30, 12288
    s_add_u32 s31, s28, 196608
    buffer_load_dwordx4 v48, s[4:7], s31 offen lds
    s_add_u32 m0, s30, 16384
    s_add_u32 s31, s29, 0
    buffer_load_dwordx4 v49, s[8:11], s31 offen lds
    s_add_u32 m0, s30, 20480
    s_add_u32 s31, s29, 196608
    buffer_load_dwordx4 v49, s[8:11], s31 offen lds
    s_add_u32 m0, s30, 24576
    s_add_u32 s31, s29, 128
    buffer_load_dwordx4 v49, s[8:11], s31 offen lds
    s_add_u32 m0, s30, 28672
    s_add_u32 s31, s29, 196736
    buffer_load_dwordx4 v49, s[8:11], s31 offen lds
    s_add_u32 m0, s30, 32768
    s_add_u32 s31, s29, 256
    buffer_load_dwordx4 v49, s[8:11], s31 offen lds
    s_add_u32 m0, s30, 36864
    s_add_u32 s31, s29, 196864
    buffer_load_dwordx4 v49, s[8:11], s31 offen lds
    s_add_u32 s28, s28, 128
    s_add_u32 s29, s29, 393216
    s_add_u32 s33, s33, 1
    s_cmp_eq_u32 s33, 4
    s_cselect_b32 s31, 4294844416, s40
    s_cselect_b32 s33, 0, s33
    s_add_u32 s30, s30, s31

    s_add_u32 m0, s30, 0
    s_add_u32 s31, s28, 0
    buffer_load_dwordx4 v48, s[4:7], s31 offen lds
    s_add_u32 m0, s30, 4096
    s_add_u32 s31, s28, 65536
    buffer_load_dwordx4 v48, s[4:7], s31 offen lds
    s_add_u32 m0, s30, 8192
    s_add_u32 s31, s28, 131072
    buffer_load_dwordx4 v48, s[4:7], s31 offen lds
    s_add_u32 m0, s30, 12288
    s_add_u32 s31, s28, 196608
    buffer_load_dwordx4 v48, s[4:7], s31 offen lds
    s_add_u32 m0, s30, 16384
    s_add_u32 s31, s29, 0
    buffer_load_dwordx4 v49, s[8:11], s31 offen lds
    s_add_u32 m0, s30, 20480
    s_add_u32 s31, s29, 196608
    buffer_load_dwordx4 v49, s[8:11], s31 offen lds
    s_add_u32 m0, s30, 24576
    s_add_u32 s31, s29, 128
    buffer_load_dwordx4 v49, s[8:11], s31 offen lds
    s_add_u32 m0, s30, 28672
    s_add_u32 s31, s29, 196736
    buffer_load_dwordx4 v49, s[8:11], s31 offen lds
    s_add_u32 m0, s30, 32768
    s_add_u32 s31, s29, 256
    buffer_load_dwordx4 v49, s[8:11], s31 offen lds
    s_add_u32 m0, s30, 36864
    s_add_u32 s31, s29, 196864
    buffer_load_dwordx4 v49, s[8:11], s31 offen lds
    s_add_u32 s28, s28, 128
    s_add_u32 s29, s29, 393216
    s_add_u32 s33, s33, 1
    s_cmp_eq_u32 s33, 4
    s_cselect_b32 s31, 4294844416, s40
    s_cselect_b32 s33, 0, s33
    s_add_u32 s30, s30, s31

    s_add_u32 m0, s30, 0
    s_add_u32 s31, s28, 0
    buffer_load_dwordx4 v48, s[4:7], s31 offen lds
    s_add_u32 m0, s30, 4096
    s_add_u32 s31, s28, 65536
    buffer_load_dwordx4 v48, s[4:7], s31 offen lds
    s_add_u32 m0, s30, 8192
    s_add_u32 s31, s28, 131072
    buffer_load_dwordx4 v48, s[4:7], s31 offen lds
    s_add_u32 m0, s30, 12288
    s_add_u32 s31, s28, 196608
    buffer_load_dwordx4 v48, s[4:7], s31 offen lds
    s_add_u32 m0, s30, 16384
    s_add_u32 s31, s29, 0
    buffer_load_dwordx4 v49, s[8:11], s31 offen lds
    s_add_u32 m0, s30, 20480
    s_add_u32 s31, s29, 196608
    buffer_load_dwordx4 v49, s[8:11], s31 offen lds
    s_add_u32 m0, s30, 24576
    s_add_u32 s31, s29, 128
    buffer_load_dwordx4 v49, s[8:11], s31 offen lds
    s_add_u32 m0, s30, 28672
    s_add_u32 s31, s29, 196736
    buffer_load_dwordx4 v49, s[8:11], s31 offen lds
    s_add_u32 m0, s30, 32768
    s_add_u32 s31, s29, 256
    buffer_load_dwordx4 v49, s[8:11], s31 offen lds
    s_add_u32 m0, s30, 36864
    s_add_u32 s31, s29, 196864
    buffer_load_dwordx4 v49, s[8:11], s31 offen lds
    s_add_u32 s28, s28, 128
    s_add_u32 s29, s29, 393216
    s_add_u32 s33, s33, 1
    s_cmp_eq_u32 s33, 4
    s_cselect_b32 s31, 4294844416, s40
    s_cselect_b32 s33, 0, s33
    s_add_u32 s30, s30, s31

    s_waitcnt vmcnt(20)
    s_barrier
    s_mov_b32 s32, 0
qkv_kernel_ploop:
    s_cmp_ge_u32 s32, 13
    s_cbranch_scc1 qkv_kernel_pnoissue
    s_add_u32 m0, s30, 0
    s_add_u32 s31, s28, 0
    buffer_load_dwordx4 v48, s[4:7], s31 offen lds
    s_add_u32 m0, s30, 4096
    s_add_u32 s31, s28, 65536
    buffer_load_dwordx4 v48, s[4:7], s31 offen lds
    s_add_u32 m0, s30, 8192
    s_add_u32 s31, s28, 131072
    buffer_load_dwordx4 v48, s[4:7], s31 offen lds
    s_add_u32 m0, s30, 12288
    s_add_u32 s31, s28, 196608
    buffer_load_dwordx4 v48, s[4:7], s31 offen lds
    s_add_u32 m0, s30, 16384
    s_add_u32 s31, s29, 0
    buffer_load_dwordx4 v49, s[8:11], s31 offen lds
    s_add_u32 m0, s30, 20480
    s_add_u32 s31, s29, 196608
    buffer_load_dwordx4 v49, s[8:11], s31 offen lds
    s_add_u32 m0, s30, 24576
    s_add_u32 s31, s29, 128
    buffer_load_dwordx4 v49, s[8:11], s31 offen lds
    s_add_u32 m0, s30, 28672
    s_add_u32 s31, s29, 196736
    buffer_load_dwordx4 v49, s[8:11], s31 offen lds
    s_add_u32 m0, s30, 32768
    s_add_u32 s31, s29, 256
    buffer_load_dwordx4 v49, s[8:11], s31 offen lds
    s_add_u32 m0, s30, 36864
    s_add_u32 s31, s29, 196864
    buffer_load_dwordx4 v49, s[8:11], s31 offen lds
    s_add_u32 s28, s28, 128
    s_add_u32 s29, s29, 393216
    s_add_u32 s33, s33, 1
    s_cmp_eq_u32 s33, 4
    s_cselect_b32 s31, 4294844416, s40
    s_cselect_b32 s33, 0, s33
    s_add_u32 s30, s30, s31

    s_waitcnt vmcnt(20)
    s_branch qkv_kernel_pbar
qkv_kernel_pnoissue:
    s_waitcnt vmcnt(0)
qkv_kernel_pbar:
    s_barrier
    s_add_u32 s32, s32, 1
    s_cmp_lt_u32 s32, 15
    s_cbranch_scc1 qkv_kernel_ploop
    v_mov_b32 v5, v51
    s_mov_b32 s34, 0
    v_mov_b32 v64, s34
    s_mul_i32 s34, s25, 1366
    s_lshr_b32 s34, s34, 16
    s_add_u32 s34, s34, 64

    s_mov_b32 s34, 0

qkv_kernel_poll:
    buffer_load_dword v65, v64, s[56:59], 0 offen sc1
    s_waitcnt vmcnt(0)
    v_cmp_le_u32 vcc, 256, v65
    s_add_u32 s34, s34, 1
    s_and_b32 s35, vcc_lo, 3
    s_cmp_eq_u32 s35, 3
    s_cbranch_scc1 qkv_kernel_polldone
    s_cmp_ge_u32 s34, 0x100000
    s_cbranch_scc1 qkv_kernel_polldone
    s_sleep 2
    s_branch qkv_kernel_poll

qkv_kernel_polldone:
    s_lshl_b32 s34, s27, 6
    v_add_u32 v64, s34, v0
    v_add_u32 v65, s25, v64
    v_lshlrev_b32 v65, 2, v65

    s_mov_b32 s35, 0
    buffer_load_dword v68, v65, s[48:51], s35 offen sc1
    s_mov_b32 s35, 12288
    buffer_load_dword v69, v65, s[48:51], s35 offen sc1
    s_mov_b32 s35, 24576
    buffer_load_dword v70, v65, s[48:51], s35 offen sc1
    s_mov_b32 s35, 36864
    buffer_load_dword v71, v65, s[48:51], s35 offen sc1
    s_mov_b32 s35, 49152
    buffer_load_dword v72, v65, s[48:51], s35 offen sc1
    s_mov_b32 s35, 61440
    buffer_load_dword v73, v65, s[48:51], s35 offen sc1
    s_mov_b32 s35, 73728
    buffer_load_dword v74, v65, s[48:51], s35 offen sc1
    s_mov_b32 s35, 86016
    buffer_load_dword v75, v65, s[48:51], s35 offen sc1
    s_mov_b32 s35, 98304
    buffer_load_dword v76, v65, s[48:51], s35 offen sc1
    s_mov_b32 s35, 110592
    buffer_load_dword v77, v65, s[48:51], s35 offen sc1
    s_mov_b32 s35, 122880
    buffer_load_dword v78, v65, s[48:51], s35 offen sc1
    s_mov_b32 s35, 135168
    buffer_load_dword v79, v65, s[48:51], s35 offen sc1
    s_mov_b32 s35, 147456
    buffer_load_dword v80, v65, s[48:51], s35 offen sc1
    s_mov_b32 s35, 159744
    buffer_load_dword v81, v65, s[48:51], s35 offen sc1
    s_mov_b32 s35, 172032
    buffer_load_dword v82, v65, s[48:51], s35 offen sc1
    s_mov_b32 s35, 184320
    buffer_load_dword v83, v65, s[48:51], s35 offen sc1
    v_add_u32 v66, s24, v64
    v_lshlrev_b32 v66, 3, v66
    buffer_load_dwordx2 v[84:85], v66, s[44:47], 0 offen sc1

    s_waitcnt vmcnt(0)
    v_add_f32 v68, v68, v69
    v_add_f32 v70, v70, v71
    v_add_f32 v72, v72, v73
    v_add_f32 v74, v74, v75
    v_add_f32 v76, v76, v77
    v_add_f32 v78, v78, v79
    v_add_f32 v80, v80, v81
    v_add_f32 v82, v82, v83
    v_add_f32 v68, v68, v70
    v_add_f32 v72, v72, v74
    v_add_f32 v76, v76, v78
    v_add_f32 v80, v80, v82
    v_add_f32 v68, v68, v72
    v_add_f32 v76, v76, v80
    v_add_f32 v68, v68, v76
    v_lshlrev_b32 v65, 2, v64
    v_lshlrev_b32 v66, 3, v64
    v_add_u32 v65, 100352, v65
    v_add_u32 v66, 101376, v66

    s_barrier
    ds_write_b32 v65, v68
    s_cmp_ge_u32 s27, 2
    s_cbranch_scc1 qkv_kernel_nost
    ds_write_b64 v66, v[84:85]
qkv_kernel_nost:
    s_waitcnt lgkmcnt(0)
qkv_kernel_epi2:
    s_barrier
    v_lshlrev_b32 v1, 5, v195
    v_add_u32 v1, 100352, v1
    ds_read_b128 v[204:207], v1
    ds_read_b128 v[208:211], v1 offset:16
    v_cmp_gt_u32 vcc, 48, v0
    s_and_b64 exec, exec, vcc

    ds_read_b128 v[8:11], v192 offset:0
    ds_read_b128 v[12:15], v192 offset:16
    ds_read_b64 v[56:57], v194 offset:0
    ds_read_b128 v[24:27], v192 offset:1568
    ds_read_b128 v[28:31], v192 offset:1584
    ds_read_b64 v[58:59], v194 offset:16
    s_waitcnt lgkmcnt(3)
    v_pk_fma_f32 v[8:9], v[56:57], v[204:205], v[8:9] op_sel_hi:[0,1,1] neg_lo:[1,0,0] neg_hi:[1,0,0]
    v_pk_fma_f32 v[10:11], v[56:57], v[206:207], v[10:11] op_sel_hi:[0,1,1] neg_lo:[1,0,0] neg_hi:[1,0,0]
    v_pk_fma_f32 v[12:13], v[56:57], v[208:209], v[12:13] op_sel_hi:[0,1,1] neg_lo:[1,0,0] neg_hi:[1,0,0]
    v_pk_fma_f32 v[14:15], v[56:57], v[210:211], v[14:15] op_sel_hi:[0,1,1] neg_lo:[1,0,0] neg_hi:[1,0,0]
    v_pk_mul_f32 v[8:9], v[8:9], v[56:57] op_sel:[0,1] op_sel_hi:[1,1]
    v_pk_mul_f32 v[10:11], v[10:11], v[56:57] op_sel:[0,1] op_sel_hi:[1,1]
    v_pk_mul_f32 v[12:13], v[12:13], v[56:57] op_sel:[0,1] op_sel_hi:[1,1]
    v_pk_mul_f32 v[14:15], v[14:15], v[56:57] op_sel:[0,1] op_sel_hi:[1,1]
    v_cvt_pk_bf16_f32 v16, v8, v9
    v_cvt_pk_bf16_f32 v17, v10, v11
    v_cvt_pk_bf16_f32 v18, v12, v13
    v_cvt_pk_bf16_f32 v19, v14, v15
    s_mov_b32 s35, 0
    buffer_store_dwordx4 v[16:19], v193, s[12:15], s35 offen sc1
    ds_read_b128 v[8:11], v192 offset:3136
    ds_read_b128 v[12:15], v192 offset:3152
    ds_read_b64 v[56:57], v194 offset:32
    s_waitcnt lgkmcnt(3)
    v_pk_fma_f32 v[24:25], v[58:59], v[204:205], v[24:25] op_sel_hi:[0,1,1] neg_lo:[1,0,0] neg_hi:[1,0,0]
    v_pk_fma_f32 v[26:27], v[58:59], v[206:207], v[26:27] op_sel_hi:[0,1,1] neg_lo:[1,0,0] neg_hi:[1,0,0]
    v_pk_fma_f32 v[28:29], v[58:59], v[208:209], v[28:29] op_sel_hi:[0,1,1] neg_lo:[1,0,0] neg_hi:[1,0,0]
    v_pk_fma_f32 v[30:31], v[58:59], v[210:211], v[30:31] op_sel_hi:[0,1,1] neg_lo:[1,0,0] neg_hi:[1,0,0]
    v_pk_mul_f32 v[24:25], v[24:25], v[58:59] op_sel:[0,1] op_sel_hi:[1,1]
    v_pk_mul_f32 v[26:27], v[26:27], v[58:59] op_sel:[0,1] op_sel_hi:[1,1]
    v_pk_mul_f32 v[28:29], v[28:29], v[58:59] op_sel:[0,1] op_sel_hi:[1,1]
    v_pk_mul_f32 v[30:31], v[30:31], v[58:59] op_sel:[0,1] op_sel_hi:[1,1]
    v_cvt_pk_bf16_f32 v32, v24, v25
    v_cvt_pk_bf16_f32 v33, v26, v27
    v_cvt_pk_bf16_f32 v34, v28, v29
    v_cvt_pk_bf16_f32 v35, v30, v31
    s_mov_b32 s35, 128
    buffer_store_dwordx4 v[32:35], v193, s[12:15], s35 offen sc1
    ds_read_b128 v[24:27], v192 offset:4704
    ds_read_b128 v[28:31], v192 offset:4720
    ds_read_b64 v[58:59], v194 offset:48
    s_waitcnt lgkmcnt(3)
    v_pk_fma_f32 v[8:9], v[56:57], v[204:205], v[8:9] op_sel_hi:[0,1,1] neg_lo:[1,0,0] neg_hi:[1,0,0]
    v_pk_fma_f32 v[10:11], v[56:57], v[206:207], v[10:11] op_sel_hi:[0,1,1] neg_lo:[1,0,0] neg_hi:[1,0,0]
    v_pk_fma_f32 v[12:13], v[56:57], v[208:209], v[12:13] op_sel_hi:[0,1,1] neg_lo:[1,0,0] neg_hi:[1,0,0]
    v_pk_fma_f32 v[14:15], v[56:57], v[210:211], v[14:15] op_sel_hi:[0,1,1] neg_lo:[1,0,0] neg_hi:[1,0,0]
    v_pk_mul_f32 v[8:9], v[8:9], v[56:57] op_sel:[0,1] op_sel_hi:[1,1]
    v_pk_mul_f32 v[10:11], v[10:11], v[56:57] op_sel:[0,1] op_sel_hi:[1,1]
    v_pk_mul_f32 v[12:13], v[12:13], v[56:57] op_sel:[0,1] op_sel_hi:[1,1]
    v_pk_mul_f32 v[14:15], v[14:15], v[56:57] op_sel:[0,1] op_sel_hi:[1,1]
    v_cvt_pk_bf16_f32 v16, v8, v9
    v_cvt_pk_bf16_f32 v17, v10, v11
    v_cvt_pk_bf16_f32 v18, v12, v13
    v_cvt_pk_bf16_f32 v19, v14, v15
    s_mov_b32 s35, 256
    buffer_store_dwordx4 v[16:19], v193, s[12:15], s35 offen sc1
    ds_read_b128 v[8:11], v192 offset:6272
    ds_read_b128 v[12:15], v192 offset:6288
    ds_read_b64 v[56:57], v194 offset:64
    s_waitcnt lgkmcnt(3)
    v_pk_fma_f32 v[24:25], v[58:59], v[204:205], v[24:25] op_sel_hi:[0,1,1] neg_lo:[1,0,0] neg_hi:[1,0,0]
    v_pk_fma_f32 v[26:27], v[58:59], v[206:207], v[26:27] op_sel_hi:[0,1,1] neg_lo:[1,0,0] neg_hi:[1,0,0]
    v_pk_fma_f32 v[28:29], v[58:59], v[208:209], v[28:29] op_sel_hi:[0,1,1] neg_lo:[1,0,0] neg_hi:[1,0,0]
    v_pk_fma_f32 v[30:31], v[58:59], v[210:211], v[30:31] op_sel_hi:[0,1,1] neg_lo:[1,0,0] neg_hi:[1,0,0]
    v_pk_mul_f32 v[24:25], v[24:25], v[58:59] op_sel:[0,1] op_sel_hi:[1,1]
    v_pk_mul_f32 v[26:27], v[26:27], v[58:59] op_sel:[0,1] op_sel_hi:[1,1]
    v_pk_mul_f32 v[28:29], v[28:29], v[58:59] op_sel:[0,1] op_sel_hi:[1,1]
    v_pk_mul_f32 v[30:31], v[30:31], v[58:59] op_sel:[0,1] op_sel_hi:[1,1]
    v_cvt_pk_bf16_f32 v32, v24, v25
    v_cvt_pk_bf16_f32 v33, v26, v27
    v_cvt_pk_bf16_f32 v34, v28, v29
    v_cvt_pk_bf16_f32 v35, v30, v31
    s_mov_b32 s35, 384
    buffer_store_dwordx4 v[32:35], v193, s[12:15], s35 offen sc1
    ds_read_b128 v[24:27], v192 offset:7840
    ds_read_b128 v[28:31], v192 offset:7856
    ds_read_b64 v[58:59], v194 offset:80
    s_waitcnt lgkmcnt(3)
    v_pk_fma_f32 v[8:9], v[56:57], v[204:205], v[8:9] op_sel_hi:[0,1,1] neg_lo:[1,0,0] neg_hi:[1,0,0]
    v_pk_fma_f32 v[10:11], v[56:57], v[206:207], v[10:11] op_sel_hi:[0,1,1] neg_lo:[1,0,0] neg_hi:[1,0,0]
    v_pk_fma_f32 v[12:13], v[56:57], v[208:209], v[12:13] op_sel_hi:[0,1,1] neg_lo:[1,0,0] neg_hi:[1,0,0]
    v_pk_fma_f32 v[14:15], v[56:57], v[210:211], v[14:15] op_sel_hi:[0,1,1] neg_lo:[1,0,0] neg_hi:[1,0,0]
    v_pk_mul_f32 v[8:9], v[8:9], v[56:57] op_sel:[0,1] op_sel_hi:[1,1]
    v_pk_mul_f32 v[10:11], v[10:11], v[56:57] op_sel:[0,1] op_sel_hi:[1,1]
    v_pk_mul_f32 v[12:13], v[12:13], v[56:57] op_sel:[0,1] op_sel_hi:[1,1]
    v_pk_mul_f32 v[14:15], v[14:15], v[56:57] op_sel:[0,1] op_sel_hi:[1,1]
    v_cvt_pk_bf16_f32 v16, v8, v9
    v_cvt_pk_bf16_f32 v17, v10, v11
    v_cvt_pk_bf16_f32 v18, v12, v13
    v_cvt_pk_bf16_f32 v19, v14, v15
    s_mov_b32 s35, 512
    buffer_store_dwordx4 v[16:19], v193, s[12:15], s35 offen sc1
    ds_read_b128 v[8:11], v192 offset:9408
    ds_read_b128 v[12:15], v192 offset:9424
    ds_read_b64 v[56:57], v194 offset:96
    s_waitcnt lgkmcnt(3)
    v_pk_fma_f32 v[24:25], v[58:59], v[204:205], v[24:25] op_sel_hi:[0,1,1] neg_lo:[1,0,0] neg_hi:[1,0,0]
    v_pk_fma_f32 v[26:27], v[58:59], v[206:207], v[26:27] op_sel_hi:[0,1,1] neg_lo:[1,0,0] neg_hi:[1,0,0]
    v_pk_fma_f32 v[28:29], v[58:59], v[208:209], v[28:29] op_sel_hi:[0,1,1] neg_lo:[1,0,0] neg_hi:[1,0,0]
    v_pk_fma_f32 v[30:31], v[58:59], v[210:211], v[30:31] op_sel_hi:[0,1,1] neg_lo:[1,0,0] neg_hi:[1,0,0]
    v_pk_mul_f32 v[24:25], v[24:25], v[58:59] op_sel:[0,1] op_sel_hi:[1,1]
    v_pk_mul_f32 v[26:27], v[26:27], v[58:59] op_sel:[0,1] op_sel_hi:[1,1]
    v_pk_mul_f32 v[28:29], v[28:29], v[58:59] op_sel:[0,1] op_sel_hi:[1,1]
    v_pk_mul_f32 v[30:31], v[30:31], v[58:59] op_sel:[0,1] op_sel_hi:[1,1]
    v_cvt_pk_bf16_f32 v32, v24, v25
    v_cvt_pk_bf16_f32 v33, v26, v27
    v_cvt_pk_bf16_f32 v34, v28, v29
    v_cvt_pk_bf16_f32 v35, v30, v31
    s_mov_b32 s35, 640
    buffer_store_dwordx4 v[32:35], v193, s[12:15], s35 offen sc1
    ds_read_b128 v[24:27], v192 offset:10976
    ds_read_b128 v[28:31], v192 offset:10992
    ds_read_b64 v[58:59], v194 offset:112
    s_waitcnt lgkmcnt(3)
    v_pk_fma_f32 v[8:9], v[56:57], v[204:205], v[8:9] op_sel_hi:[0,1,1] neg_lo:[1,0,0] neg_hi:[1,0,0]
    v_pk_fma_f32 v[10:11], v[56:57], v[206:207], v[10:11] op_sel_hi:[0,1,1] neg_lo:[1,0,0] neg_hi:[1,0,0]
    v_pk_fma_f32 v[12:13], v[56:57], v[208:209], v[12:13] op_sel_hi:[0,1,1] neg_lo:[1,0,0] neg_hi:[1,0,0]
    v_pk_fma_f32 v[14:15], v[56:57], v[210:211], v[14:15] op_sel_hi:[0,1,1] neg_lo:[1,0,0] neg_hi:[1,0,0]
    v_pk_mul_f32 v[8:9], v[8:9], v[56:57] op_sel:[0,1] op_sel_hi:[1,1]
    v_pk_mul_f32 v[10:11], v[10:11], v[56:57] op_sel:[0,1] op_sel_hi:[1,1]
    v_pk_mul_f32 v[12:13], v[12:13], v[56:57] op_sel:[0,1] op_sel_hi:[1,1]
    v_pk_mul_f32 v[14:15], v[14:15], v[56:57] op_sel:[0,1] op_sel_hi:[1,1]
    v_cvt_pk_bf16_f32 v16, v8, v9
    v_cvt_pk_bf16_f32 v17, v10, v11
    v_cvt_pk_bf16_f32 v18, v12, v13
    v_cvt_pk_bf16_f32 v19, v14, v15
    s_mov_b32 s35, 768
    buffer_store_dwordx4 v[16:19], v193, s[12:15], s35 offen sc1
    s_waitcnt lgkmcnt(0)
    v_pk_fma_f32 v[24:25], v[58:59], v[204:205], v[24:25] op_sel_hi:[0,1,1] neg_lo:[1,0,0] neg_hi:[1,0,0]
    v_pk_fma_f32 v[26:27], v[58:59], v[206:207], v[26:27] op_sel_hi:[0,1,1] neg_lo:[1,0,0] neg_hi:[1,0,0]
    v_pk_fma_f32 v[28:29], v[58:59], v[208:209], v[28:29] op_sel_hi:[0,1,1] neg_lo:[1,0,0] neg_hi:[1,0,0]
    v_pk_fma_f32 v[30:31], v[58:59], v[210:211], v[30:31] op_sel_hi:[0,1,1] neg_lo:[1,0,0] neg_hi:[1,0,0]
    v_pk_mul_f32 v[24:25], v[24:25], v[58:59] op_sel:[0,1] op_sel_hi:[1,1]
    v_pk_mul_f32 v[26:27], v[26:27], v[58:59] op_sel:[0,1] op_sel_hi:[1,1]
    v_pk_mul_f32 v[28:29], v[28:29], v[58:59] op_sel:[0,1] op_sel_hi:[1,1]
    v_pk_mul_f32 v[30:31], v[30:31], v[58:59] op_sel:[0,1] op_sel_hi:[1,1]
    v_cvt_pk_bf16_f32 v32, v24, v25
    v_cvt_pk_bf16_f32 v33, v26, v27
    v_cvt_pk_bf16_f32 v34, v28, v29
    v_cvt_pk_bf16_f32 v35, v30, v31
    s_mov_b32 s35, 896
    buffer_store_dwordx4 v[32:35], v193, s[12:15], s35 offen sc1
qkv_kernel_end:
    s_endpgm
.globl attn_kernel
.p2align 8
.type attn_kernel,@function
attn_kernel:
    s_cmp_ge_u32 s2, 256
    s_cbranch_scc1 attn_kernel_end
    s_load_dwordx2 s[4:5], s[0:1], 80
    s_load_dwordx2 s[8:9], s[0:1], 80
    s_load_dwordx2 s[80:81], s[0:1], 16
    s_load_dwordx2 s[84:85], s[0:1], 32
    s_load_dwordx2 s[96:97], s[0:1], 80
    s_and_b32 s12, s2, 31
    s_lshr_b32 s13, s2, 5
    s_lshl_b32 s13, s13, 8
    v_lshrrev_b32 v1, 6, v0
    v_and_b32 v0, 63, v0
    s_nop 0
    v_readfirstlane_b32 s14, v1
    s_waitcnt lgkmcnt(0)

    s_add_u32 s4, s4, 4194304
    s_addc_u32 s5, s5, 0
    s_and_b32 s5, s5, 0xffff
    s_mov_b32 s6, 12582912
    s_mov_b32 s7, 0x00020000
    s_add_u32 s8, s8, 16777216
    s_addc_u32 s9, s9, 0
    s_and_b32 s9, s9, 0xffff
    s_mov_b32 s10, 4194304
    s_mov_b32 s11, 0x00020000
    s_and_b32 s81, s81, 0xffff
    s_mov_b32 s82, 2097152
    s_mov_b32 s83, 0x00020000
    s_and_b32 s85, s85, 0xffff
    s_mov_b32 s86, 7340032
    s_mov_b32 s87, 0x00020000
    s_add_u32 s96, s96, 47185920
    s_addc_u32 s97, s97, 0
    s_and_b32 s97, s97, 0xffff
    s_mov_b32 s98, 229376
    s_mov_b32 s99, 0x00020000
    s_lshl_b32 s16, s14, 5
    s_add_u32 s15, s13, s16
    s_mul_i32 s17, s12, 131072

    v_lshrrev_b32 v1, 2, v0
    s_lshl_b32 s16, s14, 6
    s_add_u32 s16, s16, s13
    s_sub_u32 s16, s16, 256
    v_add_u32 v1, s16, v1
    v_cmp_gt_i32 vcc, 0, v1
    v_lshlrev_b32 v1, 6, v1
    v_and_b32 v2, 3, v0
    v_lshrrev_b32 v3, 4, v0
    v_xor_b32 v3, v3, v2
    v_add_u32 v1, s17, v1
    v_lshl_add_u32 v4, v3, 4, v1
    v_lshl_add_u32 v5, v2, 4, v1
    v_add_u32 v4, 4194304, v4
    v_add_u32 v5, 8388608, v5
    v_mov_b32 v6, 0x7ff00000
    v_cndmask_b32 v4, v4, v6, vcc
    v_cndmask_b32 v5, v5, v6, vcc
    s_lshl_b32 s20, s14, 12

    s_mov_b32 m0, s20
    s_nop 0
    buffer_load_dwordx4 v4, s[4:7], 0 offen offset:0 lds
    buffer_load_dwordx4 v4, s[4:7], 0 offen offset:1024 lds
    buffer_load_dwordx4 v4, s[4:7], 0 offen offset:2048 lds
    buffer_load_dwordx4 v4, s[4:7], 0 offen offset:3072 lds
    v_and_b32 v2, 31, v0
    v_lshrrev_b32 v3, 5, v0
    v_add_u32 v4, s15, v2
    v_lshlrev_b32 v4, 6, v4
    v_lshl_add_u32 v4, v3, 4, v4
    v_add_u32 v4, s17, v4
    buffer_load_dwordx4 v[8:11], v4, s[4:7], 0 offen
    buffer_load_dwordx4 v[12:15], v4, s[4:7], 0 offen offset:32

    s_add_u32 m0, s20, 32768
    s_nop 0
    buffer_load_dwordx4 v5, s[4:7], 0 offen offset:0 lds
    buffer_load_dwordx4 v5, s[4:7], 0 offen offset:1024 lds
    buffer_load_dwordx4 v5, s[4:7], 0 offen offset:2048 lds
    buffer_load_dwordx4 v5, s[4:7], 0 offen offset:3072 lds
    v_mov_b32 v232, 0
    v_mov_b32 v233, 0
    v_mov_b32 v234, 0
    v_mov_b32 v235, 0
    v_mov_b32 v236, 0
    v_mov_b32 v237, 0
    v_mov_b32 v238, 0
    v_mov_b32 v239, 0
    v_mov_b32 v240, 0
    v_mov_b32 v241, 0
    v_mov_b32 v242, 0
    v_mov_b32 v243, 0
    v_mov_b32 v244, 0
    v_mov_b32 v245, 0
    v_mov_b32 v246, 0
    v_mov_b32 v247, 0
    v_lshlrev_b32 v6, 2, v3
    v_sub_u32 v6, v2, v6

    s_lshl_b32 s16, s14, 5
    v_add_u32 v4, s16, v2
    v_lshrrev_b32 v5, 2, v2
    v_and_b32 v5, 3, v5
    v_xor_b32 v5, v5, v3
    v_lshlrev_b32 v4, 6, v4
    v_lshl_add_u32 v4, v5, 4, v4
    v_xor_b32 v5, 32, v4

    s_waitcnt vmcnt(4)
    s_barrier

    ds_read_b128 v[16:19], v4 offset:0
    ds_read_b128 v[20:23], v5 offset:0
    ds_read_b128 v[24:27], v4 offset:2048
    ds_read_b128 v[28:31], v5 offset:2048
    s_waitcnt lgkmcnt(2)
    v_mfma_f32_32x32x16_bf16 v[88:103], v[16:19], v[8:11], 0
    v_mfma_f32_32x32x16_bf16 v[88:103], v[20:23], v[12:15], v[88:103]
    ds_read_b128 v[16:19], v4 offset:4096
    ds_read_b128 v[20:23], v5 offset:4096
    s_waitcnt lgkmcnt(2)
    v_mfma_f32_32x32x16_bf16 v[104:119], v[24:27], v[8:11], 0
    v_mfma_f32_32x32x16_bf16 v[104:119], v[28:31], v[12:15], v[104:119]
    ds_read_b128 v[24:27], v4 offset:6144
    ds_read_b128 v[28:31], v5 offset:6144
    s_waitcnt lgkmcnt(2)
    v_mfma_f32_32x32x16_bf16 v[120:135], v[16:19], v[8:11], 0
    v_mfma_f32_32x32x16_bf16 v[120:135], v[20:23], v[12:15], v[120:135]
    ds_read_b128 v[16:19], v4 offset:8192
    ds_read_b128 v[20:23], v5 offset:8192
    s_waitcnt lgkmcnt(2)
    v_mfma_f32_32x32x16_bf16 v[136:151], v[24:27], v[8:11], 0
    v_mfma_f32_32x32x16_bf16 v[136:151], v[28:31], v[12:15], v[136:151]
    ds_read_b128 v[24:27], v4 offset:10240
    ds_read_b128 v[28:31], v5 offset:10240
    s_waitcnt lgkmcnt(2)
    v_mfma_f32_32x32x16_bf16 v[152:167], v[16:19], v[8:11], 0
    v_mfma_f32_32x32x16_bf16 v[152:167], v[20:23], v[12:15], v[152:167]
    ds_read_b128 v[16:19], v4 offset:12288
    ds_read_b128 v[20:23], v5 offset:12288
    s_waitcnt lgkmcnt(2)
    v_mfma_f32_32x32x16_bf16 v[168:183], v[24:27], v[8:11], 0
    v_mfma_f32_32x32x16_bf16 v[168:183], v[28:31], v[12:15], v[168:183]
    ds_read_b128 v[24:27], v4 offset:14336
    ds_read_b128 v[28:31], v5 offset:14336
    s_waitcnt lgkmcnt(2)
    v_mfma_f32_32x32x16_bf16 v[184:199], v[16:19], v[8:11], 0
    v_mfma_f32_32x32x16_bf16 v[184:199], v[20:23], v[12:15], v[184:199]
    ds_read_b128 v[16:19], v4 offset:16384
    ds_read_b128 v[20:23], v5 offset:16384
    s_waitcnt lgkmcnt(2)
    v_mfma_f32_32x32x16_bf16 v[200:215], v[24:27], v[8:11], 0
    v_mfma_f32_32x32x16_bf16 v[200:215], v[28:31], v[12:15], v[200:215]
    s_waitcnt lgkmcnt(0)
    v_mfma_f32_32x32x16_bf16 v[216:231], v[16:19], v[8:11], 0
    v_mfma_f32_32x32x16_bf16 v[216:231], v[20:23], v[12:15], v[216:231]
    s_waitcnt vmcnt(0)
    s_barrier
    s_lshl_b32 s21, s2, 3
    s_add_u32 s21, s21, s14
    s_mul_i32 s16, s21, 1024
    v_lshlrev_b32 v252, 4, v0
    v_add_u32 v252, s16, v252
    buffer_load_dwordx4 v[248:251], v252, s[80:83], 0 offen offset:0
    s_lshr_b32 s16, s2, 4
    s_lshl_b32 s16, s16, 6
    s_lshl_b32 s18, s14, 3
    s_add_u32 s16, s16, s18
    v_lshrrev_b32 v253, 5, v0
    v_add_u32 v253, s16, v253
    s_mov_b32 s16, 7168
    v_mul_lo_u32 v253, v253, s16
    v_and_b32 v252, 31, v0
    v_min_u32 v252, 27, v252
    v_lshl_add_u32 v253, v252, 4, v253
    s_and_b32 s16, s2, 15
    s_mul_i32 s16, s16, 448
    v_add_u32 v253, s16, v253

    s_mov_b32 s16, 0
    buffer_load_dwordx4 v[48:51], v253, s[84:87], s16 offen
    s_mov_b32 s16, 14336
    buffer_load_dwordx4 v[52:55], v253, s[84:87], s16 offen
    s_mov_b32 s16, 28672
    buffer_load_dwordx4 v[56:59], v253, s[84:87], s16 offen
    s_mov_b32 s16, 43008
    buffer_load_dwordx4 v[60:63], v253, s[84:87], s16 offen
    v_mov_b32 v7, 0xf149f2ca
    v_cmp_le_i32 s[24:25], 0, v6
    v_cmp_le_i32 s[26:27], 1, v6
    v_cmp_le_i32 s[28:29], 2, v6
    v_cmp_le_i32 s[30:31], 3, v6
    v_cmp_le_i32 s[32:33], 8, v6
    v_cmp_le_i32 s[34:35], 9, v6
    v_cmp_le_i32 s[36:37], 10, v6
    v_cmp_le_i32 s[38:39], 11, v6
    v_cmp_le_i32 s[40:41], 16, v6
    v_cmp_le_i32 s[42:43], 17, v6
    v_cmp_le_i32 s[44:45], 18, v6
    v_cmp_le_i32 s[46:47], 19, v6
    v_cmp_le_i32 s[48:49], 24, v6
    v_cmp_le_i32 s[50:51], 25, v6
    v_cmp_le_i32 s[52:53], 26, v6
    v_cmp_le_i32 s[54:55], 27, v6
    v_cndmask_b32 v88, v88, v7, s[24:25]
    v_cndmask_b32 v89, v89, v7, s[26:27]
    v_cndmask_b32 v90, v90, v7, s[28:29]
    v_cndmask_b32 v91, v91, v7, s[30:31]
    v_cndmask_b32 v92, v92, v7, s[32:33]
    v_cndmask_b32 v93, v93, v7, s[34:35]
    v_cndmask_b32 v94, v94, v7, s[36:37]
    v_cndmask_b32 v95, v95, v7, s[38:39]
    v_cndmask_b32 v96, v96, v7, s[40:41]
    v_cndmask_b32 v97, v97, v7, s[42:43]
    v_cndmask_b32 v98, v98, v7, s[44:45]
    v_cndmask_b32 v99, v99, v7, s[46:47]
    v_cndmask_b32 v100, v100, v7, s[48:49]
    v_cndmask_b32 v101, v101, v7, s[50:51]
    v_cndmask_b32 v102, v102, v7, s[52:53]
    v_cndmask_b32 v103, v103, v7, s[54:55]
    s_nop 3
    v_cndmask_b32 v216, v7, v216, s[24:25]
    v_cndmask_b32 v217, v7, v217, s[26:27]
    v_cndmask_b32 v218, v7, v218, s[28:29]
    v_cndmask_b32 v219, v7, v219, s[30:31]
    v_cndmask_b32 v220, v7, v220, s[32:33]
    v_cndmask_b32 v221, v7, v221, s[34:35]
    v_cndmask_b32 v222, v7, v222, s[36:37]
    v_cndmask_b32 v223, v7, v223, s[38:39]
    v_cndmask_b32 v224, v7, v224, s[40:41]
    v_cndmask_b32 v225, v7, v225, s[42:43]
    v_cndmask_b32 v226, v7, v226, s[44:45]
    v_cndmask_b32 v227, v7, v227, s[46:47]
    v_cndmask_b32 v228, v7, v228, s[48:49]
    v_cndmask_b32 v229, v7, v229, s[50:51]
    v_cndmask_b32 v230, v7, v230, s[52:53]
    v_cndmask_b32 v231, v7, v231, s[54:55]
    s_add_u32 s21, s15, 0
    s_cmp_ge_u32 s21, 256
    s_cbranch_scc1 attn_kernel_nofill
    v_mov_b32 v88, v7
    v_mov_b32 v89, v7
    v_mov_b32 v90, v7
    v_mov_b32 v91, v7
    v_mov_b32 v92, v7
    v_mov_b32 v93, v7
    v_mov_b32 v94, v7
    v_mov_b32 v95, v7
    v_mov_b32 v96, v7
    v_mov_b32 v97, v7
    v_mov_b32 v98, v7
    v_mov_b32 v99, v7
    v_mov_b32 v100, v7
    v_mov_b32 v101, v7
    v_mov_b32 v102, v7
    v_mov_b32 v103, v7
    s_add_u32 s21, s15, 32
    s_cmp_ge_u32 s21, 256
    s_cbranch_scc1 attn_kernel_nofill
    v_mov_b32 v104, v7
    v_mov_b32 v105, v7
    v_mov_b32 v106, v7
    v_mov_b32 v107, v7
    v_mov_b32 v108, v7
    v_mov_b32 v109, v7
    v_mov_b32 v110, v7
    v_mov_b32 v111, v7
    v_mov_b32 v112, v7
    v_mov_b32 v113, v7
    v_mov_b32 v114, v7
    v_mov_b32 v115, v7
    v_mov_b32 v116, v7
    v_mov_b32 v117, v7
    v_mov_b32 v118, v7
    v_mov_b32 v119, v7
    s_add_u32 s21, s15, 64
    s_cmp_ge_u32 s21, 256
    s_cbranch_scc1 attn_kernel_nofill
    v_mov_b32 v120, v7
    v_mov_b32 v121, v7
    v_mov_b32 v122, v7
    v_mov_b32 v123, v7
    v_mov_b32 v124, v7
    v_mov_b32 v125, v7
    v_mov_b32 v126, v7
    v_mov_b32 v127, v7
    v_mov_b32 v128, v7
    v_mov_b32 v129, v7
    v_mov_b32 v130, v7
    v_mov_b32 v131, v7
    v_mov_b32 v132, v7
    v_mov_b32 v133, v7
    v_mov_b32 v134, v7
    v_mov_b32 v135, v7
    s_add_u32 s21, s15, 96
    s_cmp_ge_u32 s21, 256
    s_cbranch_scc1 attn_kernel_nofill
    v_mov_b32 v136, v7
    v_mov_b32 v137, v7
    v_mov_b32 v138, v7
    v_mov_b32 v139, v7
    v_mov_b32 v140, v7
    v_mov_b32 v141, v7
    v_mov_b32 v142, v7
    v_mov_b32 v143, v7
    v_mov_b32 v144, v7
    v_mov_b32 v145, v7
    v_mov_b32 v146, v7
    v_mov_b32 v147, v7
    v_mov_b32 v148, v7
    v_mov_b32 v149, v7
    v_mov_b32 v150, v7
    v_mov_b32 v151, v7
    s_add_u32 s21, s15, 128
    s_cmp_ge_u32 s21, 256
    s_cbranch_scc1 attn_kernel_nofill
    v_mov_b32 v152, v7
    v_mov_b32 v153, v7
    v_mov_b32 v154, v7
    v_mov_b32 v155, v7
    v_mov_b32 v156, v7
    v_mov_b32 v157, v7
    v_mov_b32 v158, v7
    v_mov_b32 v159, v7
    v_mov_b32 v160, v7
    v_mov_b32 v161, v7
    v_mov_b32 v162, v7
    v_mov_b32 v163, v7
    v_mov_b32 v164, v7
    v_mov_b32 v165, v7
    v_mov_b32 v166, v7
    v_mov_b32 v167, v7
    s_add_u32 s21, s15, 160
    s_cmp_ge_u32 s21, 256
    s_cbranch_scc1 attn_kernel_nofill
    v_mov_b32 v168, v7
    v_mov_b32 v169, v7
    v_mov_b32 v170, v7
    v_mov_b32 v171, v7
    v_mov_b32 v172, v7
    v_mov_b32 v173, v7
    v_mov_b32 v174, v7
    v_mov_b32 v175, v7
    v_mov_b32 v176, v7
    v_mov_b32 v177, v7
    v_mov_b32 v178, v7
    v_mov_b32 v179, v7
    v_mov_b32 v180, v7
    v_mov_b32 v181, v7
    v_mov_b32 v182, v7
    v_mov_b32 v183, v7
    s_add_u32 s21, s15, 192
    s_cmp_ge_u32 s21, 256
    s_cbranch_scc1 attn_kernel_nofill
    v_mov_b32 v184, v7
    v_mov_b32 v185, v7
    v_mov_b32 v186, v7
    v_mov_b32 v187, v7
    v_mov_b32 v188, v7
    v_mov_b32 v189, v7
    v_mov_b32 v190, v7
    v_mov_b32 v191, v7
    v_mov_b32 v192, v7
    v_mov_b32 v193, v7
    v_mov_b32 v194, v7
    v_mov_b32 v195, v7
    v_mov_b32 v196, v7
    v_mov_b32 v197, v7
    v_mov_b32 v198, v7
    v_mov_b32 v199, v7
    s_add_u32 s21, s15, 224
    s_cmp_ge_u32 s21, 256
    s_cbranch_scc1 attn_kernel_nofill
    v_mov_b32 v200, v7
    v_mov_b32 v201, v7
    v_mov_b32 v202, v7
    v_mov_b32 v203, v7
    v_mov_b32 v204, v7
    v_mov_b32 v205, v7
    v_mov_b32 v206, v7
    v_mov_b32 v207, v7
    v_mov_b32 v208, v7
    v_mov_b32 v209, v7
    v_mov_b32 v210, v7
    v_mov_b32 v211, v7
    v_mov_b32 v212, v7
    v_mov_b32 v213, v7
    v_mov_b32 v214, v7
    v_mov_b32 v215, v7
attn_kernel_nofill:
    v_max3_f32 v1, v88, v89, v90
    v_max3_f32 v2, v91, v92, v93
    v_max3_f32 v1, v1, v94, v95
    v_max3_f32 v2, v2, v96, v97
    v_max3_f32 v1, v1, v98, v99
    v_max3_f32 v2, v2, v100, v101
    v_max3_f32 v1, v1, v102, v103
    v_max3_f32 v2, v2, v104, v105
    v_max3_f32 v1, v1, v106, v107
    v_max3_f32 v2, v2, v108, v109
    v_max3_f32 v1, v1, v110, v111
    v_max3_f32 v2, v2, v112, v113
    v_max3_f32 v1, v1, v114, v115
    v_max3_f32 v2, v2, v116, v117
    v_max3_f32 v1, v1, v118, v119
    v_max3_f32 v2, v2, v120, v121
    v_max3_f32 v1, v1, v122, v123
    v_max3_f32 v2, v2, v124, v125
    v_max3_f32 v1, v1, v126, v127
    v_max3_f32 v2, v2, v128, v129
    v_max3_f32 v1, v1, v130, v131
    v_max3_f32 v2, v2, v132, v133
    v_max3_f32 v1, v1, v134, v135
    v_max3_f32 v2, v2, v136, v137
    v_max3_f32 v1, v1, v138, v139
    v_max3_f32 v2, v2, v140, v141
    v_max3_f32 v1, v1, v142, v143
    v_max3_f32 v2, v2, v144, v145
    v_max3_f32 v1, v1, v146, v147
    v_max3_f32 v2, v2, v148, v149
    v_max3_f32 v1, v1, v150, v151
    v_max3_f32 v2, v2, v152, v153
    v_max3_f32 v1, v1, v154, v155
    v_max3_f32 v2, v2, v156, v157
    v_max3_f32 v1, v1, v158, v159
    v_max3_f32 v2, v2, v160, v161
    v_max3_f32 v1, v1, v162, v163
    v_max3_f32 v2, v2, v164, v165
    v_max3_f32 v1, v1, v166, v167
    v_max3_f32 v2, v2, v168, v169
    v_max3_f32 v1, v1, v170, v171
    v_max3_f32 v2, v2, v172, v173
    v_max3_f32 v1, v1, v174, v175
    v_max3_f32 v2, v2, v176, v177
    v_max3_f32 v1, v1, v178, v179
    v_max3_f32 v2, v2, v180, v181
    v_max3_f32 v1, v1, v182, v183
    v_max3_f32 v2, v2, v184, v185
    v_max3_f32 v1, v1, v186, v187
    v_max3_f32 v2, v2, v188, v189
    v_max3_f32 v1, v1, v190, v191
    v_max3_f32 v2, v2, v192, v193
    v_max3_f32 v1, v1, v194, v195
    v_max3_f32 v2, v2, v196, v197
    v_max3_f32 v1, v1, v198, v199
    v_max3_f32 v2, v2, v200, v201
    v_max3_f32 v1, v1, v202, v203
    v_max3_f32 v2, v2, v204, v205
    v_max3_f32 v1, v1, v206, v207
    v_max3_f32 v2, v2, v208, v209
    v_max3_f32 v1, v1, v210, v211
    v_max3_f32 v2, v2, v212, v213
    v_max3_f32 v1, v1, v214, v215
    v_max3_f32 v2, v2, v216, v217
    v_max3_f32 v1, v1, v218, v219
    v_max3_f32 v2, v2, v220, v221
    v_max3_f32 v1, v1, v222, v223
    v_max3_f32 v2, v2, v224, v225
    v_max3_f32 v1, v1, v226, v227
    v_max3_f32 v2, v2, v228, v229
    v_max3_f32 v1, v1, v230, v231
    v_max_f32 v1, v1, v2
    v_mov_b32 v2, v1
    s_nop 1
    v_permlane32_swap_b32 v1, v2
    s_nop 1
    v_max_f32 v1, v1, v2
    s_mov_b32 s22, 0x3e8293ee
    s_mov_b32 s23, 0x3e8293ee
    v_mul_f32 v2, s22, v1
    v_sub_f32 v2, 0, v2
    v_mov_b32 v3, v2

    v_lshrrev_b32 v4, 2, v0
    v_and_b32 v4, 3, v4
    v_lshrrev_b32 v5, 5, v0
    v_lshl_add_u32 v4, v5, 2, v4
    s_lshl_b32 s16, s14, 5
    v_add_u32 v4, s16, v4
    v_lshlrev_b32 v4, 6, v4
    v_lshrrev_b32 v5, 4, v0
    v_and_b32 v5, 1, v5
    v_lshl_add_u32 v4, v5, 5, v4
    v_and_b32 v5, 3, v0
    v_lshl_add_u32 v4, v5, 3, v4
    v_add_u32 v4, 32768, v4
    v_mov_b32 v8, 0x3f803f80
    v_mov_b32 v9, 0x3f803f80
    v_mov_b32 v10, 0x3f803f80
    v_mov_b32 v11, 0x3f803f80

    v_mov_b32 v16, 0
    v_mov_b32 v17, 0
    v_mov_b32 v18, 0
    v_mov_b32 v19, 0
    v_mov_b32 v20, 0
    v_mov_b32 v21, 0
    v_mov_b32 v22, 0
    v_mov_b32 v23, 0
    v_mov_b32 v24, 0
    v_mov_b32 v25, 0
    v_mov_b32 v26, 0
    v_mov_b32 v27, 0
    v_mov_b32 v28, 0
    v_mov_b32 v29, 0
    v_mov_b32 v30, 0
    v_mov_b32 v31, 0
    ds_read_b64_tr_b16 v[32:33], v4 offset:0
    ds_read_b64_tr_b16 v[34:35], v4 offset:512
    ds_read_b64_tr_b16 v[36:37], v4 offset:1024
    ds_read_b64_tr_b16 v[38:39], v4 offset:1536
    v_pk_fma_f32 v[88:89], v[88:89], s[22:23], v[2:3]
    v_pk_fma_f32 v[90:91], v[90:91], s[22:23], v[2:3]
    v_pk_fma_f32 v[92:93], v[92:93], s[22:23], v[2:3]
    v_pk_fma_f32 v[94:95], v[94:95], s[22:23], v[2:3]
    v_pk_fma_f32 v[96:97], v[96:97], s[22:23], v[2:3]
    v_pk_fma_f32 v[98:99], v[98:99], s[22:23], v[2:3]
    v_pk_fma_f32 v[100:101], v[100:101], s[22:23], v[2:3]
    v_pk_fma_f32 v[102:103], v[102:103], s[22:23], v[2:3]
    v_exp_f32 v88, v88
    v_exp_f32 v89, v89
    v_exp_f32 v90, v90
    v_exp_f32 v91, v91
    v_exp_f32 v92, v92
    v_exp_f32 v93, v93
    v_exp_f32 v94, v94
    v_exp_f32 v95, v95
    v_exp_f32 v96, v96
    v_exp_f32 v97, v97
    v_exp_f32 v98, v98
    v_exp_f32 v99, v99
    v_exp_f32 v100, v100
    v_exp_f32 v101, v101
    v_exp_f32 v102, v102
    v_exp_f32 v103, v103
    v_cvt_pk_bf16_f32 v88, v88, v89
    v_cvt_pk_bf16_f32 v89, v90, v91
    v_cvt_pk_bf16_f32 v90, v92, v93
    v_cvt_pk_bf16_f32 v91, v94, v95
    v_cvt_pk_bf16_f32 v92, v96, v97
    v_cvt_pk_bf16_f32 v93, v98, v99
    v_cvt_pk_bf16_f32 v94, v100, v101
    v_cvt_pk_bf16_f32 v95, v102, v103
    ds_read_b64_tr_b16 v[40:41], v4 offset:2048
    ds_read_b64_tr_b16 v[42:43], v4 offset:2560
    ds_read_b64_tr_b16 v[44:45], v4 offset:3072
    ds_read_b64_tr_b16 v[46:47], v4 offset:3584
    v_pk_fma_f32 v[104:105], v[104:105], s[22:23], v[2:3]
    v_pk_fma_f32 v[106:107], v[106:107], s[22:23], v[2:3]
    v_pk_fma_f32 v[108:109], v[108:109], s[22:23], v[2:3]
    v_mfma_f32_32x32x16_bf16 v[16:31], v[8:11], v[88:91], v[16:31]
    v_pk_fma_f32 v[110:111], v[110:111], s[22:23], v[2:3]
    v_pk_fma_f32 v[112:113], v[112:113], s[22:23], v[2:3]
    v_pk_fma_f32 v[114:115], v[114:115], s[22:23], v[2:3]
    v_pk_fma_f32 v[116:117], v[116:117], s[22:23], v[2:3]
    v_pk_fma_f32 v[118:119], v[118:119], s[22:23], v[2:3]
    v_exp_f32 v104, v104
    v_exp_f32 v105, v105
    v_exp_f32 v106, v106
    v_mfma_f32_32x32x16_bf16 v[16:31], v[8:11], v[92:95], v[16:31]
    v_exp_f32 v107, v107
    v_exp_f32 v108, v108
    v_exp_f32 v109, v109
    v_exp_f32 v110, v110
    v_exp_f32 v111, v111
    v_exp_f32 v112, v112
    v_exp_f32 v113, v113
    v_exp_f32 v114, v114
    s_waitcnt lgkmcnt(4)
    v_mfma_f32_32x32x16_bf16 v[232:247], v[32:35], v[88:91], v[232:247]
    v_exp_f32 v115, v115
    v_exp_f32 v116, v116
    v_exp_f32 v117, v117
    v_exp_f32 v118, v118
    v_exp_f32 v119, v119
    v_cvt_pk_bf16_f32 v104, v104, v105
    v_cvt_pk_bf16_f32 v105, v106, v107
    v_cvt_pk_bf16_f32 v106, v108, v109
    v_mfma_f32_32x32x16_bf16 v[232:247], v[36:39], v[92:95], v[232:247]
    v_cvt_pk_bf16_f32 v107, v110, v111
    v_cvt_pk_bf16_f32 v108, v112, v113
    v_cvt_pk_bf16_f32 v109, v114, v115
    v_cvt_pk_bf16_f32 v110, v116, v117
    v_cvt_pk_bf16_f32 v111, v118, v119
    ds_read_b64_tr_b16 v[32:33], v4 offset:4096
    ds_read_b64_tr_b16 v[34:35], v4 offset:4608
    ds_read_b64_tr_b16 v[36:37], v4 offset:5120
    ds_read_b64_tr_b16 v[38:39], v4 offset:5632
    v_pk_fma_f32 v[120:121], v[120:121], s[22:23], v[2:3]
    v_pk_fma_f32 v[122:123], v[122:123], s[22:23], v[2:3]
    v_pk_fma_f32 v[124:125], v[124:125], s[22:23], v[2:3]
    v_mfma_f32_32x32x16_bf16 v[16:31], v[8:11], v[104:107], v[16:31]
    v_pk_fma_f32 v[126:127], v[126:127], s[22:23], v[2:3]
    v_pk_fma_f32 v[128:129], v[128:129], s[22:23], v[2:3]
    v_pk_fma_f32 v[130:131], v[130:131], s[22:23], v[2:3]
    v_pk_fma_f32 v[132:133], v[132:133], s[22:23], v[2:3]
    v_pk_fma_f32 v[134:135], v[134:135], s[22:23], v[2:3]
    v_exp_f32 v120, v120
    v_exp_f32 v121, v121
    v_exp_f32 v122, v122
    v_mfma_f32_32x32x16_bf16 v[16:31], v[8:11], v[108:111], v[16:31]
    v_exp_f32 v123, v123
    v_exp_f32 v124, v124
    v_exp_f32 v125, v125
    v_exp_f32 v126, v126
    v_exp_f32 v127, v127
    v_exp_f32 v128, v128
    v_exp_f32 v129, v129
    v_exp_f32 v130, v130
    s_waitcnt lgkmcnt(4)
    v_mfma_f32_32x32x16_bf16 v[232:247], v[40:43], v[104:107], v[232:247]
    v_exp_f32 v131, v131
    v_exp_f32 v132, v132
    v_exp_f32 v133, v133
    v_exp_f32 v134, v134
    v_exp_f32 v135, v135
    v_cvt_pk_bf16_f32 v120, v120, v121
    v_cvt_pk_bf16_f32 v121, v122, v123
    v_cvt_pk_bf16_f32 v122, v124, v125
    v_mfma_f32_32x32x16_bf16 v[232:247], v[44:47], v[108:111], v[232:247]
    v_cvt_pk_bf16_f32 v123, v126, v127
    v_cvt_pk_bf16_f32 v124, v128, v129
    v_cvt_pk_bf16_f32 v125, v130, v131
    v_cvt_pk_bf16_f32 v126, v132, v133
    v_cvt_pk_bf16_f32 v127, v134, v135
    ds_read_b64_tr_b16 v[40:41], v4 offset:6144
    ds_read_b64_tr_b16 v[42:43], v4 offset:6656
    ds_read_b64_tr_b16 v[44:45], v4 offset:7168
    ds_read_b64_tr_b16 v[46:47], v4 offset:7680
    v_pk_fma_f32 v[136:137], v[136:137], s[22:23], v[2:3]
    v_pk_fma_f32 v[138:139], v[138:139], s[22:23], v[2:3]
    v_pk_fma_f32 v[140:141], v[140:141], s[22:23], v[2:3]
    v_mfma_f32_32x32x16_bf16 v[16:31], v[8:11], v[120:123], v[16:31]
    v_pk_fma_f32 v[142:143], v[142:143], s[22:23], v[2:3]
    v_pk_fma_f32 v[144:145], v[144:145], s[22:23], v[2:3]
    v_pk_fma_f32 v[146:147], v[146:147], s[22:23], v[2:3]
    v_pk_fma_f32 v[148:149], v[148:149], s[22:23], v[2:3]
    v_pk_fma_f32 v[150:151], v[150:151], s[22:23], v[2:3]
    v_exp_f32 v136, v136
    v_exp_f32 v137, v137
    v_exp_f32 v138, v138
    v_mfma_f32_32x32x16_bf16 v[16:31], v[8:11], v[124:127], v[16:31]
    v_exp_f32 v139, v139
    v_exp_f32 v140, v140
    v_exp_f32 v141, v141
    v_exp_f32 v142, v142
    v_exp_f32 v143, v143
    v_exp_f32 v144, v144
    v_exp_f32 v145, v145
    v_exp_f32 v146, v146
    s_waitcnt lgkmcnt(4)
    v_mfma_f32_32x32x16_bf16 v[232:247], v[32:35], v[120:123], v[232:247]
    v_exp_f32 v147, v147
    v_exp_f32 v148, v148
    v_exp_f32 v149, v149
    v_exp_f32 v150, v150
    v_exp_f32 v151, v151
    v_cvt_pk_bf16_f32 v136, v136, v137
    v_cvt_pk_bf16_f32 v137, v138, v139
    v_cvt_pk_bf16_f32 v138, v140, v141
    v_mfma_f32_32x32x16_bf16 v[232:247], v[36:39], v[124:127], v[232:247]
    v_cvt_pk_bf16_f32 v139, v142, v143
    v_cvt_pk_bf16_f32 v140, v144, v145
    v_cvt_pk_bf16_f32 v141, v146, v147
    v_cvt_pk_bf16_f32 v142, v148, v149
    v_cvt_pk_bf16_f32 v143, v150, v151
    ds_read_b64_tr_b16 v[32:33], v4 offset:8192
    ds_read_b64_tr_b16 v[34:35], v4 offset:8704
    ds_read_b64_tr_b16 v[36:37], v4 offset:9216
    ds_read_b64_tr_b16 v[38:39], v4 offset:9728
    v_pk_fma_f32 v[152:153], v[152:153], s[22:23], v[2:3]
    v_pk_fma_f32 v[154:155], v[154:155], s[22:23], v[2:3]
    v_pk_fma_f32 v[156:157], v[156:157], s[22:23], v[2:3]
    v_mfma_f32_32x32x16_bf16 v[16:31], v[8:11], v[136:139], v[16:31]
    v_pk_fma_f32 v[158:159], v[158:159], s[22:23], v[2:3]
    v_pk_fma_f32 v[160:161], v[160:161], s[22:23], v[2:3]
    v_pk_fma_f32 v[162:163], v[162:163], s[22:23], v[2:3]
    v_pk_fma_f32 v[164:165], v[164:165], s[22:23], v[2:3]
    v_pk_fma_f32 v[166:167], v[166:167], s[22:23], v[2:3]
    v_exp_f32 v152, v152
    v_exp_f32 v153, v153
    v_exp_f32 v154, v154
    v_mfma_f32_32x32x16_bf16 v[16:31], v[8:11], v[140:143], v[16:31]
    v_exp_f32 v155, v155
    v_exp_f32 v156, v156
    v_exp_f32 v157, v157
    v_exp_f32 v158, v158
    v_exp_f32 v159, v159
    v_exp_f32 v160, v160
    v_exp_f32 v161, v161
    v_exp_f32 v162, v162
    s_waitcnt lgkmcnt(4)
    v_mfma_f32_32x32x16_bf16 v[232:247], v[40:43], v[136:139], v[232:247]
    v_exp_f32 v163, v163
    v_exp_f32 v164, v164
    v_exp_f32 v165, v165
    v_exp_f32 v166, v166
    v_exp_f32 v167, v167
    v_cvt_pk_bf16_f32 v152, v152, v153
    v_cvt_pk_bf16_f32 v153, v154, v155
    v_cvt_pk_bf16_f32 v154, v156, v157
    v_mfma_f32_32x32x16_bf16 v[232:247], v[44:47], v[140:143], v[232:247]
    v_cvt_pk_bf16_f32 v155, v158, v159
    v_cvt_pk_bf16_f32 v156, v160, v161
    v_cvt_pk_bf16_f32 v157, v162, v163
    v_cvt_pk_bf16_f32 v158, v164, v165
    v_cvt_pk_bf16_f32 v159, v166, v167
    ds_read_b64_tr_b16 v[40:41], v4 offset:10240
    ds_read_b64_tr_b16 v[42:43], v4 offset:10752
    ds_read_b64_tr_b16 v[44:45], v4 offset:11264
    ds_read_b64_tr_b16 v[46:47], v4 offset:11776
    v_pk_fma_f32 v[168:169], v[168:169], s[22:23], v[2:3]
    v_pk_fma_f32 v[170:171], v[170:171], s[22:23], v[2:3]
    v_pk_fma_f32 v[172:173], v[172:173], s[22:23], v[2:3]
    v_mfma_f32_32x32x16_bf16 v[16:31], v[8:11], v[152:155], v[16:31]
    v_pk_fma_f32 v[174:175], v[174:175], s[22:23], v[2:3]
    v_pk_fma_f32 v[176:177], v[176:177], s[22:23], v[2:3]
    v_pk_fma_f32 v[178:179], v[178:179], s[22:23], v[2:3]
    v_pk_fma_f32 v[180:181], v[180:181], s[22:23], v[2:3]
    v_pk_fma_f32 v[182:183], v[182:183], s[22:23], v[2:3]
    v_exp_f32 v168, v168
    v_exp_f32 v169, v169
    v_exp_f32 v170, v170
    v_mfma_f32_32x32x16_bf16 v[16:31], v[8:11], v[156:159], v[16:31]
    v_exp_f32 v171, v171
    v_exp_f32 v172, v172
    v_exp_f32 v173, v173
    v_exp_f32 v174, v174
    v_exp_f32 v175, v175
    v_exp_f32 v176, v176
    v_exp_f32 v177, v177
    v_exp_f32 v178, v178
    s_waitcnt lgkmcnt(4)
    v_mfma_f32_32x32x16_bf16 v[232:247], v[32:35], v[152:155], v[232:247]
    v_exp_f32 v179, v179
    v_exp_f32 v180, v180
    v_exp_f32 v181, v181
    v_exp_f32 v182, v182
    v_exp_f32 v183, v183
    v_cvt_pk_bf16_f32 v168, v168, v169
    v_cvt_pk_bf16_f32 v169, v170, v171
    v_cvt_pk_bf16_f32 v170, v172, v173
    v_mfma_f32_32x32x16_bf16 v[232:247], v[36:39], v[156:159], v[232:247]
    v_cvt_pk_bf16_f32 v171, v174, v175
    v_cvt_pk_bf16_f32 v172, v176, v177
    v_cvt_pk_bf16_f32 v173, v178, v179
    v_cvt_pk_bf16_f32 v174, v180, v181
    v_cvt_pk_bf16_f32 v175, v182, v183
    ds_read_b64_tr_b16 v[32:33], v4 offset:12288
    ds_read_b64_tr_b16 v[34:35], v4 offset:12800
    ds_read_b64_tr_b16 v[36:37], v4 offset:13312
    ds_read_b64_tr_b16 v[38:39], v4 offset:13824
    v_pk_fma_f32 v[184:185], v[184:185], s[22:23], v[2:3]
    v_pk_fma_f32 v[186:187], v[186:187], s[22:23], v[2:3]
    v_pk_fma_f32 v[188:189], v[188:189], s[22:23], v[2:3]
    v_mfma_f32_32x32x16_bf16 v[16:31], v[8:11], v[168:171], v[16:31]
    v_pk_fma_f32 v[190:191], v[190:191], s[22:23], v[2:3]
    v_pk_fma_f32 v[192:193], v[192:193], s[22:23], v[2:3]
    v_pk_fma_f32 v[194:195], v[194:195], s[22:23], v[2:3]
    v_pk_fma_f32 v[196:197], v[196:197], s[22:23], v[2:3]
    v_pk_fma_f32 v[198:199], v[198:199], s[22:23], v[2:3]
    v_exp_f32 v184, v184
    v_exp_f32 v185, v185
    v_exp_f32 v186, v186
    v_mfma_f32_32x32x16_bf16 v[16:31], v[8:11], v[172:175], v[16:31]
    v_exp_f32 v187, v187
    v_exp_f32 v188, v188
    v_exp_f32 v189, v189
    v_exp_f32 v190, v190
    v_exp_f32 v191, v191
    v_exp_f32 v192, v192
    v_exp_f32 v193, v193
    v_exp_f32 v194, v194
    s_waitcnt lgkmcnt(4)
    v_mfma_f32_32x32x16_bf16 v[232:247], v[40:43], v[168:171], v[232:247]
    v_exp_f32 v195, v195
    v_exp_f32 v196, v196
    v_exp_f32 v197, v197
    v_exp_f32 v198, v198
    v_exp_f32 v199, v199
    v_cvt_pk_bf16_f32 v184, v184, v185
    v_cvt_pk_bf16_f32 v185, v186, v187
    v_cvt_pk_bf16_f32 v186, v188, v189
    v_mfma_f32_32x32x16_bf16 v[232:247], v[44:47], v[172:175], v[232:247]
    v_cvt_pk_bf16_f32 v187, v190, v191
    v_cvt_pk_bf16_f32 v188, v192, v193
    v_cvt_pk_bf16_f32 v189, v194, v195
    v_cvt_pk_bf16_f32 v190, v196, v197
    v_cvt_pk_bf16_f32 v191, v198, v199
    ds_read_b64_tr_b16 v[40:41], v4 offset:14336
    ds_read_b64_tr_b16 v[42:43], v4 offset:14848
    ds_read_b64_tr_b16 v[44:45], v4 offset:15360
    ds_read_b64_tr_b16 v[46:47], v4 offset:15872
    v_pk_fma_f32 v[200:201], v[200:201], s[22:23], v[2:3]
    v_pk_fma_f32 v[202:203], v[202:203], s[22:23], v[2:3]
    v_pk_fma_f32 v[204:205], v[204:205], s[22:23], v[2:3]
    v_mfma_f32_32x32x16_bf16 v[16:31], v[8:11], v[184:187], v[16:31]
    v_pk_fma_f32 v[206:207], v[206:207], s[22:23], v[2:3]
    v_pk_fma_f32 v[208:209], v[208:209], s[22:23], v[2:3]
    v_pk_fma_f32 v[210:211], v[210:211], s[22:23], v[2:3]
    v_pk_fma_f32 v[212:213], v[212:213], s[22:23], v[2:3]
    v_pk_fma_f32 v[214:215], v[214:215], s[22:23], v[2:3]
    v_exp_f32 v200, v200
    v_exp_f32 v201, v201
    v_exp_f32 v202, v202
    v_mfma_f32_32x32x16_bf16 v[16:31], v[8:11], v[188:191], v[16:31]
    v_exp_f32 v203, v203
    v_exp_f32 v204, v204
    v_exp_f32 v205, v205
    v_exp_f32 v206, v206
    v_exp_f32 v207, v207
    v_exp_f32 v208, v208
    v_exp_f32 v209, v209
    v_exp_f32 v210, v210
    s_waitcnt lgkmcnt(4)
    v_mfma_f32_32x32x16_bf16 v[232:247], v[32:35], v[184:187], v[232:247]
    v_exp_f32 v211, v211
    v_exp_f32 v212, v212
    v_exp_f32 v213, v213
    v_exp_f32 v214, v214
    v_exp_f32 v215, v215
    v_cvt_pk_bf16_f32 v200, v200, v201
    v_cvt_pk_bf16_f32 v201, v202, v203
    v_cvt_pk_bf16_f32 v202, v204, v205
    v_mfma_f32_32x32x16_bf16 v[232:247], v[36:39], v[188:191], v[232:247]
    v_cvt_pk_bf16_f32 v203, v206, v207
    v_cvt_pk_bf16_f32 v204, v208, v209
    v_cvt_pk_bf16_f32 v205, v210, v211
    v_cvt_pk_bf16_f32 v206, v212, v213
    v_cvt_pk_bf16_f32 v207, v214, v215
    ds_read_b64_tr_b16 v[32:33], v4 offset:16384
    ds_read_b64_tr_b16 v[34:35], v4 offset:16896
    ds_read_b64_tr_b16 v[36:37], v4 offset:17408
    ds_read_b64_tr_b16 v[38:39], v4 offset:17920
    v_pk_fma_f32 v[216:217], v[216:217], s[22:23], v[2:3]
    v_pk_fma_f32 v[218:219], v[218:219], s[22:23], v[2:3]
    v_pk_fma_f32 v[220:221], v[220:221], s[22:23], v[2:3]
    v_mfma_f32_32x32x16_bf16 v[16:31], v[8:11], v[200:203], v[16:31]
    v_pk_fma_f32 v[222:223], v[222:223], s[22:23], v[2:3]
    v_pk_fma_f32 v[224:225], v[224:225], s[22:23], v[2:3]
    v_pk_fma_f32 v[226:227], v[226:227], s[22:23], v[2:3]
    v_pk_fma_f32 v[228:229], v[228:229], s[22:23], v[2:3]
    v_pk_fma_f32 v[230:231], v[230:231], s[22:23], v[2:3]
    v_exp_f32 v216, v216
    v_exp_f32 v217, v217
    v_exp_f32 v218, v218
    v_mfma_f32_32x32x16_bf16 v[16:31], v[8:11], v[204:207], v[16:31]
    v_exp_f32 v219, v219
    v_exp_f32 v220, v220
    v_exp_f32 v221, v221
    v_exp_f32 v222, v222
    v_exp_f32 v223, v223
    v_exp_f32 v224, v224
    v_exp_f32 v225, v225
    v_exp_f32 v226, v226
    s_waitcnt lgkmcnt(4)
    v_mfma_f32_32x32x16_bf16 v[232:247], v[40:43], v[200:203], v[232:247]
    v_exp_f32 v227, v227
    v_exp_f32 v228, v228
    v_exp_f32 v229, v229
    v_exp_f32 v230, v230
    v_exp_f32 v231, v231
    v_cvt_pk_bf16_f32 v216, v216, v217
    v_cvt_pk_bf16_f32 v217, v218, v219
    v_cvt_pk_bf16_f32 v218, v220, v221
    v_mfma_f32_32x32x16_bf16 v[232:247], v[44:47], v[204:207], v[232:247]
    v_cvt_pk_bf16_f32 v219, v222, v223
    v_cvt_pk_bf16_f32 v220, v224, v225
    v_cvt_pk_bf16_f32 v221, v226, v227
    v_cvt_pk_bf16_f32 v222, v228, v229
    v_cvt_pk_bf16_f32 v223, v230, v231
    s_nop 1
    v_mfma_f32_32x32x16_bf16 v[16:31], v[8:11], v[216:219], v[16:31]
    v_mfma_f32_32x32x16_bf16 v[16:31], v[8:11], v[220:223], v[16:31]
    s_waitcnt lgkmcnt(0)
    v_mfma_f32_32x32x16_bf16 v[232:247], v[32:35], v[216:219], v[232:247]
    v_mfma_f32_32x32x16_bf16 v[232:247], v[36:39], v[220:223], v[232:247]
    v_and_b32 v4, 31, v0
    v_lshrrev_b32 v5, 5, v0
    v_add_u32 v4, s15, v4
    v_lshlrev_b32 v4, 11, v4
    v_lshl_add_u32 v4, v5, 3, v4
    s_lshl_b32 s18, s12, 6
    v_add_u32 v4, s18, v4
    s_nop 7
    s_nop 3
    v_rcp_f32 v2, v16
    s_nop 0

    v_mul_f32 v232, v232, v2
    v_mul_f32 v233, v233, v2
    v_mul_f32 v234, v234, v2
    v_mul_f32 v235, v235, v2
    v_cvt_pk_bf16_f32 v232, v232, v233
    v_cvt_pk_bf16_f32 v233, v234, v235
    buffer_store_dwordx2 v[232:233], v4, s[8:11], 0 offen offset:0
    v_mul_f32 v236, v236, v2
    v_mul_f32 v237, v237, v2
    v_mul_f32 v238, v238, v2
    v_mul_f32 v239, v239, v2
    v_cvt_pk_bf16_f32 v236, v236, v237
    v_cvt_pk_bf16_f32 v237, v238, v239
    buffer_store_dwordx2 v[236:237], v4, s[8:11], 0 offen offset:16
    v_mul_f32 v240, v240, v2
    v_mul_f32 v241, v241, v2
    v_mul_f32 v242, v242, v2
    v_mul_f32 v243, v243, v2
    v_cvt_pk_bf16_f32 v240, v240, v241
    v_cvt_pk_bf16_f32 v241, v242, v243
    buffer_store_dwordx2 v[240:241], v4, s[8:11], 0 offen offset:32
    v_mul_f32 v244, v244, v2
    v_mul_f32 v245, v245, v2
    v_mul_f32 v246, v246, v2
    v_mul_f32 v247, v247, v2
    v_cvt_pk_bf16_f32 v244, v244, v245
    v_cvt_pk_bf16_f32 v245, v246, v247
    buffer_store_dwordx2 v[244:245], v4, s[8:11], 0 offen offset:48
    s_waitcnt vmcnt(4)
    v_lshlrev_b32 v64, 16, v48
    v_and_b32 v65, 0xffff0000, v48
    v_lshlrev_b32 v66, 16, v49
    v_and_b32 v67, 0xffff0000, v49
    v_lshlrev_b32 v68, 16, v50
    v_and_b32 v69, 0xffff0000, v50
    v_lshlrev_b32 v70, 16, v51
    v_and_b32 v71, 0xffff0000, v51
    v_lshlrev_b32 v72, 16, v52
    v_and_b32 v73, 0xffff0000, v52
    v_lshlrev_b32 v74, 16, v53
    v_and_b32 v75, 0xffff0000, v53
    v_lshlrev_b32 v76, 16, v54
    v_and_b32 v77, 0xffff0000, v54
    v_lshlrev_b32 v78, 16, v55
    v_and_b32 v79, 0xffff0000, v55
    v_add_f32 v64, v64, v72
    v_add_f32 v65, v65, v73
    v_add_f32 v66, v66, v74
    v_add_f32 v67, v67, v75
    v_add_f32 v68, v68, v76
    v_add_f32 v69, v69, v77
    v_add_f32 v70, v70, v78
    v_add_f32 v71, v71, v79
    v_lshlrev_b32 v72, 16, v56
    v_and_b32 v73, 0xffff0000, v56
    v_lshlrev_b32 v74, 16, v57
    v_and_b32 v75, 0xffff0000, v57
    v_lshlrev_b32 v76, 16, v58
    v_and_b32 v77, 0xffff0000, v58
    v_lshlrev_b32 v78, 16, v59
    v_and_b32 v79, 0xffff0000, v59
    v_add_f32 v64, v64, v72
    v_add_f32 v65, v65, v73
    v_add_f32 v66, v66, v74
    v_add_f32 v67, v67, v75
    v_add_f32 v68, v68, v76
    v_add_f32 v69, v69, v77
    v_add_f32 v70, v70, v78
    v_add_f32 v71, v71, v79
    v_lshlrev_b32 v72, 16, v60
    v_and_b32 v73, 0xffff0000, v60
    v_lshlrev_b32 v74, 16, v61
    v_and_b32 v75, 0xffff0000, v61
    v_lshlrev_b32 v76, 16, v62
    v_and_b32 v77, 0xffff0000, v62
    v_lshlrev_b32 v78, 16, v63
    v_and_b32 v79, 0xffff0000, v63
    v_add_f32 v64, v64, v72
    v_add_f32 v65, v65, v73
    v_add_f32 v66, v66, v74
    v_add_f32 v67, v67, v75
    v_add_f32 v68, v68, v76
    v_add_f32 v69, v69, v77
    v_add_f32 v70, v70, v78
    v_add_f32 v71, v71, v79
    v_mov_b32 v72, v64
    v_mov_b32 v73, v65
    v_mov_b32 v74, v66
    v_mov_b32 v75, v67
    v_mov_b32 v76, v68
    v_mov_b32 v77, v69
    v_mov_b32 v78, v70
    v_mov_b32 v79, v71
    s_nop 1
    v_permlane32_swap_b32 v64, v72
    v_permlane32_swap_b32 v65, v73
    v_permlane32_swap_b32 v66, v74
    v_permlane32_swap_b32 v67, v75
    v_permlane32_swap_b32 v68, v76
    v_permlane32_swap_b32 v69, v77
    v_permlane32_swap_b32 v70, v78
    v_permlane32_swap_b32 v71, v79
    s_nop 1
    v_add_f32 v64, v64, v72
    v_add_f32 v65, v65, v73
    v_add_f32 v66, v66, v74
    v_add_f32 v67, v67, v75
    v_add_f32 v68, v68, v76
    v_add_f32 v69, v69, v77
    v_add_f32 v70, v70, v78
    v_add_f32 v71, v71, v79
    s_mul_i32 s16, s14, 896
    s_add_u32 s16, s16, 65536
    v_lshlrev_b32 v1, 5, v0
    v_add_u32 v1, s16, v1
    s_mov_b64 exec, 0xfffffff
    ds_write_b128 v1, v[64:67]
    ds_write_b128 v1, v[68:71] offset:16
    s_mov_b64 exec, -1
    s_waitcnt lgkmcnt(0)
    s_barrier
    s_lshl_b32 s16, s14, 6
    v_add_u32 v1, s16, v0
    v_cmp_gt_u32 vcc, 224, v1
    s_and_saveexec_b64 s[18:19], vcc
    s_cbranch_execz attn_kernel_nocs
    v_lshlrev_b32 v1, 2, v1
    v_add_u32 v2, 65536, v1

    ds_read_b32 v64, v2 offset:0
    ds_read_b32 v65, v2 offset:896
    ds_read_b32 v66, v2 offset:1792
    ds_read_b32 v67, v2 offset:2688
    ds_read_b32 v68, v2 offset:3584
    ds_read_b32 v69, v2 offset:4480
    ds_read_b32 v70, v2 offset:5376
    ds_read_b32 v71, v2 offset:6272
    s_lshr_b32 s16, s2, 4
    s_mul_i32 s16, s16, 14336
    s_and_b32 s21, s2, 15
    s_mul_i32 s21, s21, 896
    s_add_u32 s16, s16, s21
    s_waitcnt lgkmcnt(0)
    v_add_f32 v64, v64, v65
    v_add_f32 v66, v66, v67
    v_add_f32 v68, v68, v69
    v_add_f32 v70, v70, v71
    v_add_f32 v64, v64, v66
    v_add_f32 v68, v68, v70
    v_add_f32 v64, v64, v68
    buffer_store_dword v64, v1, s[96:99], s16 offen

attn_kernel_nocs:
    s_mov_b64 exec, -1
attn_kernel_end:
    s_endpgm
.globl wo_kernel
.p2align 8
.type wo_kernel,@function
wo_kernel:
    s_cmp_ge_u32 s2, 256
    s_cbranch_scc1 wo_kernel_end
    s_load_dwordx2 s[4:5], s[0:1], 80
    s_load_dwordx2 s[8:9], s[0:1], 16
    s_load_dwordx2 s[12:13], s[0:1], 80
    s_load_dwordx2 s[16:17], s[0:1], 0
    s_load_dwordx2 s[44:45], s[0:1], 80
    s_and_b32 s27, s2, 7
    s_lshr_b32 s28, s2, 3
    s_and_b32 s29, s27, 1
    s_lshl_b32 s29, s29, 3
    s_and_b32 s30, s28, 7
    s_add_u32 s29, s29, s30
    s_lshr_b32 s30, s27, 1
    s_lshl_b32 s30, s30, 2
    s_lshr_b32 s31, s28, 3
    s_add_u32 s30, s30, s31
    s_mov_b32 s41, 0

    s_lshl_b32 s24, s29, 7
    s_mul_i32 s25, s30, 64
    v_lshrrev_b32 v1, 6, v0
    v_and_b32 v0, 63, v0
    s_mov_b32 s40, 24576
    v_readfirstlane_b32 s26, v1

    v_lshrrev_b32 v1, 3, v0
    v_and_b32 v95, 7, v0
    s_lshl_b32 s32, s26, 4
    v_add_u32 v1, s32, v1
    s_mul_i32 s34, s41, 64
    s_add_u32 s33, s25, s34
    s_mov_b32 s35, 272
    v_mul_lo_u32 v92, v1, s35
    v_lshl_add_u32 v92, v95, 5, v92
    s_lshl_b32 s34, s34, 2
    v_add_u32 v92, s34, v92
    v_add_u32 v2, s24, v1
    v_lshlrev_b32 v5, 4, v95
    s_lshl_b32 s34, s33, 1
    v_add_u32 v5, s34, v5

    s_mov_b32 s35, 2048
    v_mul_lo_u32 v93, v2, s35
    v_add_u32 v93, v93, v5

    v_lshlrev_b32 v94, 7, v2
    s_lshr_b32 s35, s25, 6
    s_lshl_b32 s35, s35, 3
    v_add_u32 v94, s35, v94

    s_waitcnt lgkmcnt(0)
    s_add_u32 s4, s4, 16777216
    s_addc_u32 s5, s5, 0
    s_and_b32 s5, s5, 0xffff
    s_mov_b32 s6, 4194304
    s_mov_b32 s7, 0x00020000
    s_and_b32 s9, s9, 0xffff
    s_mov_b32 s10, 2097152
    s_mov_b32 s11, 0x00020000
    s_add_u32 s12, s12, 20971520
    s_addc_u32 s13, s13, 0
    s_and_b32 s13, s13, 0xffff
    s_mov_b32 s14, 4194304
    s_mov_b32 s15, 0x00020000
    s_and_b32 s17, s17, 0xffff
    s_mov_b32 s18, 4194304
    s_mov_b32 s19, 0x00020000
    s_add_u32 s44, s44, 46137344
    s_addc_u32 s45, s45, 0
    s_and_b32 s45, s45, 0xffff
    s_mov_b32 s46, 262144
    s_mov_b32 s47, 0x00020000
    s_cmp_ge_u32 s26, 4
    s_cbranch_scc1 wo_kernel_prod
    s_mov_b32 s35, 0
    buffer_load_dwordx4 v[104:107], v93, s[16:19], s35 offen
    s_mov_b32 s35, 16384
    buffer_load_dwordx4 v[108:111], v93, s[16:19], s35 offen
    s_and_b32 s30, s26, 1
    s_lshr_b32 s31, s26, 1
    v_and_b32 v1, 15, v0
    v_lshrrev_b32 v2, 4, v0

    v_lshrrev_b32 v3, 1, v1
    v_xor_b32 v3, v3, v2
    v_lshlrev_b32 v3, 4, v3
    s_lshl_b32 s32, s30, 13
    v_lshlrev_b32 v4, 7, v1
    v_add_u32 v4, s32, v4
    v_add_u32 v56, v4, v3
    v_xor_b32 v57, 64, v56

    v_lshrrev_b32 v3, 2, v1
    v_lshrrev_b32 v4, 1, v3
    v_and_b32 v5, 1, v2
    v_lshlrev_b32 v5, 1, v5
    v_or_b32 v4, v4, v5
    v_lshlrev_b32 v5, 3, v2
    v_add_u32 v5, v5, v3
    v_lshlrev_b32 v5, 7, v5
    v_and_b32 v6, 3, v0
    v_lshlrev_b32 v6, 3, v6
    v_add_u32 v5, v5, v6
    v_add_u32 v5, 16384, v5
    s_mul_i32 s32, s31, 2

    s_add_u32 s33, s32, 0
    s_lshr_b32 s34, s33, 2
    s_lshl_b32 s34, s34, 13
    s_and_b32 s33, s33, 3
    v_xor_b32 v6, s33, v4
    v_lshlrev_b32 v6, 5, v6
    v_add_u32 v6, s34, v6
    v_add_u32 v58, v6, v5

    s_add_u32 s33, s32, 1
    s_lshr_b32 s34, s33, 2
    s_lshl_b32 s34, s34, 13
    s_and_b32 s33, s33, 3
    v_xor_b32 v6, s33, v4
    v_lshlrev_b32 v6, 5, v6
    v_add_u32 v6, s34, v6
    v_add_u32 v59, v6, v5

    v_mov_b32 v60, 0
    v_mov_b32 v61, 0
    v_mov_b32 v62, 0
    v_mov_b32 v63, 0
    v_mov_b32 v64, 0
    v_mov_b32 v65, 0
    v_mov_b32 v66, 0
    v_mov_b32 v67, 0
    v_mov_b32 v68, 0
    v_mov_b32 v69, 0
    v_mov_b32 v70, 0
    v_mov_b32 v71, 0
    v_mov_b32 v72, 0
    v_mov_b32 v73, 0
    v_mov_b32 v74, 0
    v_mov_b32 v75, 0
    v_mov_b32 v76, 0
    v_mov_b32 v77, 0
    v_mov_b32 v78, 0
    v_mov_b32 v79, 0
    v_mov_b32 v80, 0
    v_mov_b32 v81, 0
    v_mov_b32 v82, 0
    v_mov_b32 v83, 0
    v_mov_b32 v84, 0
    v_mov_b32 v85, 0
    v_mov_b32 v86, 0
    v_mov_b32 v87, 0
    v_mov_b32 v88, 0
    v_mov_b32 v89, 0
    v_mov_b32 v90, 0
    v_mov_b32 v91, 0
    s_barrier
    ds_read_b128 v[8:11], v56 offset:0
    ds_read_b128 v[12:15], v56 offset:2048
    ds_read_b128 v[16:19], v56 offset:4096
    ds_read_b128 v[20:23], v56 offset:6144
    ds_read_b64_tr_b16 v[40:41], v58 offset:0
    ds_read_b64_tr_b16 v[42:43], v58 offset:512
    ds_read_b64_tr_b16 v[44:45], v59 offset:0
    ds_read_b64_tr_b16 v[46:47], v59 offset:512
    s_mov_b32 s28, 0
    s_mov_b32 s29, 0
wo_kernel_cloop:
    s_waitcnt lgkmcnt(0)
    v_mfma_f32_16x16x32_bf16 v[60:63], v[40:43], v[8:11], v[60:63]
    ds_read_b128 v[24:27], v57 offset:0
    v_mfma_f32_16x16x32_bf16 v[64:67], v[40:43], v[12:15], v[64:67]
    ds_read_b128 v[28:31], v57 offset:2048
    v_mfma_f32_16x16x32_bf16 v[68:71], v[40:43], v[16:19], v[68:71]
    ds_read_b128 v[32:35], v57 offset:4096
    v_mfma_f32_16x16x32_bf16 v[72:75], v[40:43], v[20:23], v[72:75]
    ds_read_b128 v[36:39], v57 offset:6144
    v_mfma_f32_16x16x32_bf16 v[76:79], v[44:47], v[8:11], v[76:79]
    ds_read_b64_tr_b16 v[48:49], v58 offset:4096
    v_mfma_f32_16x16x32_bf16 v[80:83], v[44:47], v[12:15], v[80:83]
    ds_read_b64_tr_b16 v[50:51], v58 offset:4608
    v_mfma_f32_16x16x32_bf16 v[84:87], v[44:47], v[16:19], v[84:87]
    ds_read_b64_tr_b16 v[52:53], v59 offset:4096
    v_mfma_f32_16x16x32_bf16 v[88:91], v[44:47], v[20:23], v[88:91]
    ds_read_b64_tr_b16 v[54:55], v59 offset:4608
    s_add_u32 s29, s29, 1
    s_cmp_eq_u32 s29, 6
    s_cselect_b32 s27, 4294844416, s40
    s_cselect_b32 s29, 0, s29
    s_add_u32 s28, s28, 1
    v_add_u32 v56, s27, v56
    v_add_u32 v57, s27, v57
    v_add_u32 v58, s27, v58
    v_add_u32 v59, s27, v59
    s_waitcnt lgkmcnt(0)
    s_cmp_eq_u32 s28, 16
    s_cbranch_scc1 wo_kernel_clast
    s_barrier

    v_mfma_f32_16x16x32_bf16 v[60:63], v[48:51], v[24:27], v[60:63]
    ds_read_b128 v[8:11], v56 offset:0
    v_mfma_f32_16x16x32_bf16 v[64:67], v[48:51], v[28:31], v[64:67]
    ds_read_b128 v[12:15], v56 offset:2048
    v_mfma_f32_16x16x32_bf16 v[68:71], v[48:51], v[32:35], v[68:71]
    ds_read_b128 v[16:19], v56 offset:4096
    v_mfma_f32_16x16x32_bf16 v[72:75], v[48:51], v[36:39], v[72:75]
    ds_read_b128 v[20:23], v56 offset:6144
    v_mfma_f32_16x16x32_bf16 v[76:79], v[52:55], v[24:27], v[76:79]
    ds_read_b64_tr_b16 v[40:41], v58 offset:0
    v_mfma_f32_16x16x32_bf16 v[80:83], v[52:55], v[28:31], v[80:83]
    ds_read_b64_tr_b16 v[42:43], v58 offset:512
    v_mfma_f32_16x16x32_bf16 v[84:87], v[52:55], v[32:35], v[84:87]
    ds_read_b64_tr_b16 v[44:45], v59 offset:0
    v_mfma_f32_16x16x32_bf16 v[88:91], v[52:55], v[36:39], v[88:91]
    ds_read_b64_tr_b16 v[46:47], v59 offset:512
    s_branch wo_kernel_cloop
wo_kernel_clast:
    v_mfma_f32_16x16x32_bf16 v[60:63], v[48:51], v[24:27], v[60:63]
    v_mfma_f32_16x16x32_bf16 v[64:67], v[48:51], v[28:31], v[64:67]
    v_mfma_f32_16x16x32_bf16 v[68:71], v[48:51], v[32:35], v[68:71]
    v_mfma_f32_16x16x32_bf16 v[72:75], v[48:51], v[36:39], v[72:75]
    v_mfma_f32_16x16x32_bf16 v[76:79], v[52:55], v[24:27], v[76:79]
    v_mfma_f32_16x16x32_bf16 v[80:83], v[52:55], v[28:31], v[80:83]
    v_mfma_f32_16x16x32_bf16 v[84:87], v[52:55], v[32:35], v[84:87]
    v_mfma_f32_16x16x32_bf16 v[88:91], v[52:55], v[36:39], v[88:91]
    v_and_b32 v1, 15, v0
    v_lshrrev_b32 v2, 4, v0
    s_lshl_b32 s32, s30, 6
    v_add_u32 v1, s32, v1
    s_mov_b32 s33, 272
    v_mul_lo_u32 v1, v1, s33
    s_mul_i32 s34, s31, 128
    v_lshlrev_b32 v2, 4, v2
    v_add3_u32 v1, v1, v2, s34

    s_barrier
    ds_write_b128 v1, v[60:63] offset:0
    ds_write_b128 v1, v[76:79] offset:64
    ds_write_b128 v1, v[64:67] offset:4352
    ds_write_b128 v1, v[80:83] offset:4416
    ds_write_b128 v1, v[68:71] offset:8704
    ds_write_b128 v1, v[84:87] offset:8768
    ds_write_b128 v1, v[72:75] offset:13056
    ds_write_b128 v1, v[88:91] offset:13120
    s_waitcnt lgkmcnt(0)
    s_branch wo_kernel_epi2
wo_kernel_prod:
    v_mov_b32 v51, v5
    s_sub_u32 s27, s26, 4
    v_lshrrev_b32 v1, 3, v0
    v_and_b32 v2, 7, v0
    v_lshrrev_b32 v3, 4, v0
    s_and_b32 s34, s27, 1
    s_lshl_b32 s35, s34, 2

    v_xor_b32 v4, v2, v3
    v_xor_b32 v4, s35, v4
    s_lshl_b32 s36, s27, 3
    s_add_u32 s37, s36, s24
    v_add_u32 v5, s37, v1
    s_mov_b32 s38, 2048
    v_mul_lo_u32 v5, v5, s38
    v_lshl_add_u32 v48, v4, 4, v5

    v_and_b32 v4, 1, v3
    s_lshl_b32 s35, s34, 1
    v_or_b32 v4, s35, v4
    v_lshlrev_b32 v4, 1, v4
    v_xor_b32 v4, v4, v2
    v_add_u32 v5, s36, v1
    s_mov_b32 s38, 2048
    v_mul_lo_u32 v5, v5, s38
    s_lshl_b32 s39, s25, 1

    v_add_u32 v5, s39, v5
    v_lshl_add_u32 v49, v4, 4, v5

    s_mul_i32 s28, s41, 2048
    s_mul_i32 s29, s41, 2097152
    s_lshl_b32 s30, s27, 10
    s_mov_b32 s33, 0

    s_add_u32 m0, s30, 0
    s_add_u32 s31, s28, 0
    buffer_load_dwordx4 v48, s[4:7], s31 offen lds
    s_add_u32 m0, s30, 4096
    s_add_u32 s31, s28, 65536
    buffer_load_dwordx4 v48, s[4:7], s31 offen lds
    s_add_u32 m0, s30, 8192
    s_add_u32 s31, s28, 131072
    buffer_load_dwordx4 v48, s[4:7], s31 offen lds
    s_add_u32 m0, s30, 12288
    s_add_u32 s31, s28, 196608
    buffer_load_dwordx4 v48, s[4:7], s31 offen lds
    s_add_u32 m0, s30, 16384
    s_add_u32 s31, s29, 0
    buffer_load_dwordx4 v49, s[8:11], s31 offen lds
    s_add_u32 m0, s30, 20480
    s_add_u32 s31, s29, 65536
    buffer_load_dwordx4 v49, s[8:11], s31 offen lds
    s_add_u32 s28, s28, 128
    s_add_u32 s29, s29, 131072
    s_add_u32 s33, s33, 1
    s_cmp_eq_u32 s33, 6
    s_cselect_b32 s31, 4294844416, s40
    s_cselect_b32 s33, 0, s33
    s_add_u32 s30, s30, s31

    s_add_u32 m0, s30, 0
    s_add_u32 s31, s28, 0
    buffer_load_dwordx4 v48, s[4:7], s31 offen lds
    s_add_u32 m0, s30, 4096
    s_add_u32 s31, s28, 65536
    buffer_load_dwordx4 v48, s[4:7], s31 offen lds
    s_add_u32 m0, s30, 8192
    s_add_u32 s31, s28, 131072
    buffer_load_dwordx4 v48, s[4:7], s31 offen lds
    s_add_u32 m0, s30, 12288
    s_add_u32 s31, s28, 196608
    buffer_load_dwordx4 v48, s[4:7], s31 offen lds
    s_add_u32 m0, s30, 16384
    s_add_u32 s31, s29, 0
    buffer_load_dwordx4 v49, s[8:11], s31 offen lds
    s_add_u32 m0, s30, 20480
    s_add_u32 s31, s29, 65536
    buffer_load_dwordx4 v49, s[8:11], s31 offen lds
    s_add_u32 s28, s28, 128
    s_add_u32 s29, s29, 131072
    s_add_u32 s33, s33, 1
    s_cmp_eq_u32 s33, 6
    s_cselect_b32 s31, 4294844416, s40
    s_cselect_b32 s33, 0, s33
    s_add_u32 s30, s30, s31

    s_add_u32 m0, s30, 0
    s_add_u32 s31, s28, 0
    buffer_load_dwordx4 v48, s[4:7], s31 offen lds
    s_add_u32 m0, s30, 4096
    s_add_u32 s31, s28, 65536
    buffer_load_dwordx4 v48, s[4:7], s31 offen lds
    s_add_u32 m0, s30, 8192
    s_add_u32 s31, s28, 131072
    buffer_load_dwordx4 v48, s[4:7], s31 offen lds
    s_add_u32 m0, s30, 12288
    s_add_u32 s31, s28, 196608
    buffer_load_dwordx4 v48, s[4:7], s31 offen lds
    s_add_u32 m0, s30, 16384
    s_add_u32 s31, s29, 0
    buffer_load_dwordx4 v49, s[8:11], s31 offen lds
    s_add_u32 m0, s30, 20480
    s_add_u32 s31, s29, 65536
    buffer_load_dwordx4 v49, s[8:11], s31 offen lds
    s_add_u32 s28, s28, 128
    s_add_u32 s29, s29, 131072
    s_add_u32 s33, s33, 1
    s_cmp_eq_u32 s33, 6
    s_cselect_b32 s31, 4294844416, s40
    s_cselect_b32 s33, 0, s33
    s_add_u32 s30, s30, s31

    s_add_u32 m0, s30, 0
    s_add_u32 s31, s28, 0
    buffer_load_dwordx4 v48, s[4:7], s31 offen lds
    s_add_u32 m0, s30, 4096
    s_add_u32 s31, s28, 65536
    buffer_load_dwordx4 v48, s[4:7], s31 offen lds
    s_add_u32 m0, s30, 8192
    s_add_u32 s31, s28, 131072
    buffer_load_dwordx4 v48, s[4:7], s31 offen lds
    s_add_u32 m0, s30, 12288
    s_add_u32 s31, s28, 196608
    buffer_load_dwordx4 v48, s[4:7], s31 offen lds
    s_add_u32 m0, s30, 16384
    s_add_u32 s31, s29, 0
    buffer_load_dwordx4 v49, s[8:11], s31 offen lds
    s_add_u32 m0, s30, 20480
    s_add_u32 s31, s29, 65536
    buffer_load_dwordx4 v49, s[8:11], s31 offen lds
    s_add_u32 s28, s28, 128
    s_add_u32 s29, s29, 131072
    s_add_u32 s33, s33, 1
    s_cmp_eq_u32 s33, 6
    s_cselect_b32 s31, 4294844416, s40
    s_cselect_b32 s33, 0, s33
    s_add_u32 s30, s30, s31

    s_add_u32 m0, s30, 0
    s_add_u32 s31, s28, 0
    buffer_load_dwordx4 v48, s[4:7], s31 offen lds
    s_add_u32 m0, s30, 4096
    s_add_u32 s31, s28, 65536
    buffer_load_dwordx4 v48, s[4:7], s31 offen lds
    s_add_u32 m0, s30, 8192
    s_add_u32 s31, s28, 131072
    buffer_load_dwordx4 v48, s[4:7], s31 offen lds
    s_add_u32 m0, s30, 12288
    s_add_u32 s31, s28, 196608
    buffer_load_dwordx4 v48, s[4:7], s31 offen lds
    s_add_u32 m0, s30, 16384
    s_add_u32 s31, s29, 0
    buffer_load_dwordx4 v49, s[8:11], s31 offen lds
    s_add_u32 m0, s30, 20480
    s_add_u32 s31, s29, 65536
    buffer_load_dwordx4 v49, s[8:11], s31 offen lds
    s_add_u32 s28, s28, 128
    s_add_u32 s29, s29, 131072
    s_add_u32 s33, s33, 1
    s_cmp_eq_u32 s33, 6
    s_cselect_b32 s31, 4294844416, s40
    s_cselect_b32 s33, 0, s33
    s_add_u32 s30, s30, s31

    s_waitcnt vmcnt(24)
    s_barrier
    s_mov_b32 s32, 0
wo_kernel_ploop:
    s_cmp_ge_u32 s32, 11
    s_cbranch_scc1 wo_kernel_pnoissue
    s_add_u32 m0, s30, 0
    s_add_u32 s31, s28, 0
    buffer_load_dwordx4 v48, s[4:7], s31 offen lds
    s_add_u32 m0, s30, 4096
    s_add_u32 s31, s28, 65536
    buffer_load_dwordx4 v48, s[4:7], s31 offen lds
    s_add_u32 m0, s30, 8192
    s_add_u32 s31, s28, 131072
    buffer_load_dwordx4 v48, s[4:7], s31 offen lds
    s_add_u32 m0, s30, 12288
    s_add_u32 s31, s28, 196608
    buffer_load_dwordx4 v48, s[4:7], s31 offen lds
    s_add_u32 m0, s30, 16384
    s_add_u32 s31, s29, 0
    buffer_load_dwordx4 v49, s[8:11], s31 offen lds
    s_add_u32 m0, s30, 20480
    s_add_u32 s31, s29, 65536
    buffer_load_dwordx4 v49, s[8:11], s31 offen lds
    s_add_u32 s28, s28, 128
    s_add_u32 s29, s29, 131072
    s_add_u32 s33, s33, 1
    s_cmp_eq_u32 s33, 6
    s_cselect_b32 s31, 4294844416, s40
    s_cselect_b32 s33, 0, s33
    s_add_u32 s30, s30, s31

    s_waitcnt vmcnt(24)
    s_branch wo_kernel_pbar
wo_kernel_pnoissue:
    s_waitcnt vmcnt(0)
wo_kernel_pbar:
    s_barrier
    s_add_u32 s32, s32, 1
    s_cmp_lt_u32 s32, 15
    s_cbranch_scc1 wo_kernel_ploop
    v_mov_b32 v5, v51
    s_mov_b32 s35, 0
    buffer_load_dwordx4 v[104:107], v93, s[16:19], s35 offen
    s_mov_b32 s35, 16384
    buffer_load_dwordx4 v[108:111], v93, s[16:19], s35 offen
    s_barrier
wo_kernel_epi2:
    s_barrier
    ds_read_b128 v[8:11], v92 offset:0
    ds_read_b128 v[12:15], v92 offset:16
    ds_read_b128 v[24:27], v92 offset:2176
    ds_read_b128 v[28:31], v92 offset:2192
    s_waitcnt lgkmcnt(2)
    s_waitcnt vmcnt(0)
    v_lshlrev_b32 v16, 16, v104
    v_and_b32 v17, 0xffff0000, v104
    v_lshlrev_b32 v18, 16, v105
    v_and_b32 v19, 0xffff0000, v105
    v_lshlrev_b32 v20, 16, v106
    v_and_b32 v21, 0xffff0000, v106
    v_lshlrev_b32 v22, 16, v107
    v_and_b32 v23, 0xffff0000, v107
    v_pk_add_f32 v[8:9], v[8:9], v[16:17]
    v_pk_add_f32 v[10:11], v[10:11], v[18:19]
    v_pk_add_f32 v[12:13], v[12:13], v[20:21]
    v_pk_add_f32 v[14:15], v[14:15], v[22:23]
    v_cvt_pk_bf16_f32 v16, v8, v9
    v_cvt_pk_bf16_f32 v17, v10, v11
    v_cvt_pk_bf16_f32 v18, v12, v13
    v_cvt_pk_bf16_f32 v19, v14, v15
    v_lshlrev_b32 v8, 16, v16
    v_and_b32 v9, 0xffff0000, v16
    v_lshlrev_b32 v10, 16, v17
    v_and_b32 v11, 0xffff0000, v17
    v_lshlrev_b32 v12, 16, v18
    v_and_b32 v13, 0xffff0000, v18
    v_lshlrev_b32 v14, 16, v19
    v_and_b32 v15, 0xffff0000, v19
    v_add_f32 v60, v8, v9
    v_mul_f32 v61, v8, v8
    v_add_f32 v60, v60, v10
    v_add_f32 v60, v60, v11
    v_add_f32 v60, v60, v12
    v_add_f32 v60, v60, v13
    v_add_f32 v60, v60, v14
    v_add_f32 v60, v60, v15
    v_fmac_f32 v61, v9, v9
    v_fmac_f32 v61, v10, v10
    v_fmac_f32 v61, v11, v11
    v_fmac_f32 v61, v12, v12
    v_fmac_f32 v61, v13, v13
    v_fmac_f32 v61, v14, v14
    v_fmac_f32 v61, v15, v15
    s_nop 1
    v_add_f32_dpp v60, v60, v60 quad_perm:[1,0,3,2] row_mask:0xf bank_mask:0xf
    v_add_f32_dpp v61, v61, v61 quad_perm:[1,0,3,2] row_mask:0xf bank_mask:0xf
    s_nop 1
    v_add_f32_dpp v60, v60, v60 quad_perm:[2,3,0,1] row_mask:0xf bank_mask:0xf
    v_add_f32_dpp v61, v61, v61 quad_perm:[2,3,0,1] row_mask:0xf bank_mask:0xf
    s_nop 1
    v_add_f32_dpp v60, v60, v60 row_half_mirror row_mask:0xf bank_mask:0xf
    v_add_f32_dpp v61, v61, v61 row_half_mirror row_mask:0xf bank_mask:0xf
    s_mov_b32 s35, 0
    v_cmp_eq_u32 vcc, 0, v95
    s_and_saveexec_b64 s[42:43], vcc
    buffer_store_dwordx2 v[60:61], v94, s[44:47], s35 offen
    s_mov_b64 exec, s[42:43]
    s_mov_b32 s35, 0
    buffer_store_dwordx4 v[16:19], v93, s[12:15], s35 offen sc1
    s_waitcnt lgkmcnt(0)
    v_lshlrev_b32 v32, 16, v108
    v_and_b32 v33, 0xffff0000, v108
    v_lshlrev_b32 v34, 16, v109
    v_and_b32 v35, 0xffff0000, v109
    v_lshlrev_b32 v36, 16, v110
    v_and_b32 v37, 0xffff0000, v110
    v_lshlrev_b32 v38, 16, v111
    v_and_b32 v39, 0xffff0000, v111
    v_pk_add_f32 v[24:25], v[24:25], v[32:33]
    v_pk_add_f32 v[26:27], v[26:27], v[34:35]
    v_pk_add_f32 v[28:29], v[28:29], v[36:37]
    v_pk_add_f32 v[30:31], v[30:31], v[38:39]
    v_cvt_pk_bf16_f32 v32, v24, v25
    v_cvt_pk_bf16_f32 v33, v26, v27
    v_cvt_pk_bf16_f32 v34, v28, v29
    v_cvt_pk_bf16_f32 v35, v30, v31
    v_lshlrev_b32 v24, 16, v32
    v_and_b32 v25, 0xffff0000, v32
    v_lshlrev_b32 v26, 16, v33
    v_and_b32 v27, 0xffff0000, v33
    v_lshlrev_b32 v28, 16, v34
    v_and_b32 v29, 0xffff0000, v34
    v_lshlrev_b32 v30, 16, v35
    v_and_b32 v31, 0xffff0000, v35
    v_add_f32 v60, v24, v25
    v_mul_f32 v61, v24, v24
    v_add_f32 v60, v60, v26
    v_add_f32 v60, v60, v27
    v_add_f32 v60, v60, v28
    v_add_f32 v60, v60, v29
    v_add_f32 v60, v60, v30
    v_add_f32 v60, v60, v31
    v_fmac_f32 v61, v25, v25
    v_fmac_f32 v61, v26, v26
    v_fmac_f32 v61, v27, v27
    v_fmac_f32 v61, v28, v28
    v_fmac_f32 v61, v29, v29
    v_fmac_f32 v61, v30, v30
    v_fmac_f32 v61, v31, v31
    s_nop 1
    v_add_f32_dpp v60, v60, v60 quad_perm:[1,0,3,2] row_mask:0xf bank_mask:0xf
    v_add_f32_dpp v61, v61, v61 quad_perm:[1,0,3,2] row_mask:0xf bank_mask:0xf
    s_nop 1
    v_add_f32_dpp v60, v60, v60 quad_perm:[2,3,0,1] row_mask:0xf bank_mask:0xf
    v_add_f32_dpp v61, v61, v61 quad_perm:[2,3,0,1] row_mask:0xf bank_mask:0xf
    s_nop 1
    v_add_f32_dpp v60, v60, v60 row_half_mirror row_mask:0xf bank_mask:0xf
    v_add_f32_dpp v61, v61, v61 row_half_mirror row_mask:0xf bank_mask:0xf
    s_mov_b32 s35, 1024
    v_cmp_eq_u32 vcc, 0, v95
    s_and_saveexec_b64 s[42:43], vcc
    buffer_store_dwordx2 v[60:61], v94, s[44:47], s35 offen
    s_mov_b64 exec, s[42:43]
    s_mov_b32 s35, 16384
    buffer_store_dwordx4 v[32:35], v93, s[12:15], s35 offen sc1
wo_kernel_end:
    s_endpgm
.globl w1_kernel
.p2align 8
.type w1_kernel,@function
w1_kernel:
    s_cmp_ge_u32 s2, 256
    s_cbranch_scc1 w1_kernel_end
    s_load_dwordx2 s[4:5], s[0:1], 80
    s_load_dwordx2 s[8:9], s[0:1], 32
    s_load_dwordx2 s[12:13], s[0:1], 80
    s_load_dwordx2 s[20:21], s[0:1], 40
    s_load_dwordx2 s[44:45], s[0:1], 80
    s_load_dwordx2 s[48:49], s[0:1], 80
    s_load_dwordx2 s[52:53], s[0:1], 48
    s_and_b32 s27, s2, 7
    s_lshr_b32 s28, s2, 3
    s_and_b32 s29, s27, 1
    s_lshl_b32 s29, s29, 3
    s_and_b32 s30, s28, 7
    s_add_u32 s29, s29, s30
    s_lshr_b32 s30, s27, 1
    s_lshl_b32 s30, s30, 2
    s_lshr_b32 s31, s28, 3
    s_add_u32 s30, s30, s31
    s_mov_b32 s41, 0

    s_lshl_b32 s24, s29, 7
    s_mul_i32 s25, s30, 224
    v_lshrrev_b32 v1, 6, v0
    v_and_b32 v0, 63, v0
    s_mov_b32 s40, 49152
    v_readfirstlane_b32 s26, v1

    v_cmp_le_u32 vcc, 28, v0
    v_mov_b32 v1, 0
    s_nop 1
    v_cndmask_b32 v1, 0, 1, vcc
    v_mul_u32_u24 v2, 28, v1
    v_sub_u32 v223, v0, v2

    s_lshl_b32 s32, s26, 4
    v_add_u32 v1, s32, v1
    s_mul_i32 s34, s41, 224
    s_add_u32 s33, s25, s34
    s_mov_b32 s35, 912
    v_mul_lo_u32 v220, v1, s35
    v_lshl_add_u32 v220, v223, 5, v220
    s_lshl_b32 s34, s34, 2
    v_add_u32 v220, s34, v220
    v_add_u32 v2, s24, v1
    v_lshlrev_b32 v5, 4, v223
    s_lshl_b32 s34, s33, 1
    v_add_u32 v5, s34, v5

    s_mov_b32 s35, 7168
    v_mul_lo_u32 v221, v2, s35
    v_add_u32 v221, v221, v5

    v_lshlrev_b32 v222, 3, v1
    v_add_u32 v222, 147456, v222

    s_waitcnt lgkmcnt(0)
    s_add_u32 s4, s4, 20971520
    s_addc_u32 s5, s5, 0
    s_and_b32 s5, s5, 0xffff
    s_mov_b32 s6, 4194304
    s_mov_b32 s7, 0x00020000
    s_and_b32 s9, s9, 0xffff
    s_mov_b32 s10, 7340032
    s_mov_b32 s11, 0x00020000
    s_add_u32 s12, s12, 29360128
    s_addc_u32 s13, s13, 0
    s_and_b32 s13, s13, 0xffff
    s_mov_b32 s14, 14680064
    s_mov_b32 s15, 0x00020000
    s_and_b32 s21, s21, 0xffff
    s_mov_b32 s22, 7168
    s_mov_b32 s23, 0x00020000
    s_add_u32 s44, s44, 46137344
    s_addc_u32 s45, s45, 0
    s_and_b32 s45, s45, 0xffff
    s_mov_b32 s46, 262144
    s_mov_b32 s47, 0x00020000
    s_add_u32 s48, s48, 47185920
    s_addc_u32 s49, s49, 0
    s_and_b32 s49, s49, 0xffff
    s_mov_b32 s50, 229376
    s_mov_b32 s51, 0x00020000
    s_and_b32 s53, s53, 0xffff
    s_mov_b32 s54, 7340032
    s_mov_b32 s55, 0x00020000
    s_cmp_ge_u32 s26, 4
    s_cbranch_scc1 w1_kernel_prod
    buffer_load_dwordx4 v[8:11], v5, s[20:23], 0 offen
    v_lshrrev_b32 v1, 1, v0
    s_lshl_b32 s32, s26, 5
    v_add_u32 v1, s32, v1
    v_add_u32 v2, s24, v1
    v_lshlrev_b32 v2, 7, v2
    v_and_b32 v3, 1, v0
    v_lshl_add_u32 v2, v3, 6, v2
    buffer_load_dwordx4 v[48:51], v2, s[44:47], 0 offen
    buffer_load_dwordx4 v[52:55], v2, s[44:47], 0 offen offset:16
    buffer_load_dwordx4 v[56:59], v2, s[44:47], 0 offen offset:32
    buffer_load_dwordx4 v[60:63], v2, s[44:47], 0 offen offset:48
    v_lshlrev_b32 v64, 3, v1
    v_add_u32 v64, 147456, v64

    s_and_b32 s30, s26, 1
    s_lshr_b32 s31, s26, 1
    v_and_b32 v1, 15, v0
    v_lshrrev_b32 v2, 4, v0

    v_lshrrev_b32 v3, 1, v1
    v_xor_b32 v3, v3, v2
    v_lshlrev_b32 v3, 4, v3
    s_lshl_b32 s32, s30, 13
    v_lshlrev_b32 v4, 7, v1
    v_add_u32 v4, s32, v4
    v_add_u32 v96, v4, v3
    v_xor_b32 v97, 64, v96

    v_lshrrev_b32 v3, 2, v1
    v_lshrrev_b32 v4, 1, v3
    v_and_b32 v5, 1, v2
    v_lshlrev_b32 v5, 1, v5
    v_or_b32 v4, v4, v5
    v_lshlrev_b32 v5, 3, v2
    v_add_u32 v5, v5, v3
    v_lshlrev_b32 v5, 7, v5
    v_and_b32 v6, 3, v0
    v_lshlrev_b32 v6, 3, v6
    v_add_u32 v5, v5, v6
    v_add_u32 v5, 16384, v5
    s_mul_i32 s32, s31, 7

    s_lshr_b32 s33, s25, 4
    s_and_b32 s33, s33, 2
    s_add_u32 s32, s32, s33

    s_add_u32 s33, s32, 0
    s_lshr_b32 s34, s33, 2
    s_lshl_b32 s34, s34, 13
    s_and_b32 s33, s33, 3
    v_xor_b32 v6, s33, v4
    v_lshlrev_b32 v6, 5, v6
    v_add_u32 v6, s34, v6
    v_add_u32 v98, v6, v5

    s_add_u32 s33, s32, 1
    s_lshr_b32 s34, s33, 2
    s_lshl_b32 s34, s34, 13
    s_and_b32 s33, s33, 3
    v_xor_b32 v6, s33, v4
    v_lshlrev_b32 v6, 5, v6
    v_add_u32 v6, s34, v6
    v_add_u32 v99, v6, v5

    s_add_u32 s33, s32, 2
    s_lshr_b32 s34, s33, 2
    s_lshl_b32 s34, s34, 13
    s_and_b32 s33, s33, 3
    v_xor_b32 v6, s33, v4
    v_lshlrev_b32 v6, 5, v6
    v_add_u32 v6, s34, v6
    v_add_u32 v100, v6, v5

    s_add_u32 s33, s32, 3
    s_lshr_b32 s34, s33, 2
    s_lshl_b32 s34, s34, 13
    s_and_b32 s33, s33, 3
    v_xor_b32 v6, s33, v4
    v_lshlrev_b32 v6, 5, v6
    v_add_u32 v6, s34, v6
    v_add_u32 v101, v6, v5

    s_add_u32 s33, s32, 4
    s_lshr_b32 s34, s33, 2
    s_lshl_b32 s34, s34, 13
    s_and_b32 s33, s33, 3
    v_xor_b32 v6, s33, v4
    v_lshlrev_b32 v6, 5, v6
    v_add_u32 v6, s34, v6
    v_add_u32 v102, v6, v5

    s_add_u32 s33, s32, 5
    s_lshr_b32 s34, s33, 2
    s_lshl_b32 s34, s34, 13
    s_and_b32 s33, s33, 3
    v_xor_b32 v6, s33, v4
    v_lshlrev_b32 v6, 5, v6
    v_add_u32 v6, s34, v6
    v_add_u32 v103, v6, v5

    s_add_u32 s33, s32, 6
    s_lshr_b32 s34, s33, 2
    s_lshl_b32 s34, s34, 13
    s_and_b32 s33, s33, 3
    v_xor_b32 v6, s33, v4
    v_lshlrev_b32 v6, 5, v6
    v_add_u32 v6, s34, v6
    v_add_u32 v104, v6, v5

    v_mov_b32 v108, 0
    v_mov_b32 v109, 0
    v_mov_b32 v110, 0
    v_mov_b32 v111, 0
    v_mov_b32 v112, 0
    v_mov_b32 v113, 0
    v_mov_b32 v114, 0
    v_mov_b32 v115, 0
    v_mov_b32 v116, 0
    v_mov_b32 v117, 0
    v_mov_b32 v118, 0
    v_mov_b32 v119, 0
    v_mov_b32 v120, 0
    v_mov_b32 v121, 0
    v_mov_b32 v122, 0
    v_mov_b32 v123, 0
    v_mov_b32 v124, 0
    v_mov_b32 v125, 0
    v_mov_b32 v126, 0
    v_mov_b32 v127, 0
    v_mov_b32 v128, 0
    v_mov_b32 v129, 0
    v_mov_b32 v130, 0
    v_mov_b32 v131, 0
    v_mov_b32 v132, 0
    v_mov_b32 v133, 0
    v_mov_b32 v134, 0
    v_mov_b32 v135, 0
    v_mov_b32 v136, 0
    v_mov_b32 v137, 0
    v_mov_b32 v138, 0
    v_mov_b32 v139, 0
    v_mov_b32 v140, 0
    v_mov_b32 v141, 0
    v_mov_b32 v142, 0
    v_mov_b32 v143, 0
    v_mov_b32 v144, 0
    v_mov_b32 v145, 0
    v_mov_b32 v146, 0
    v_mov_b32 v147, 0
    v_mov_b32 v148, 0
    v_mov_b32 v149, 0
    v_mov_b32 v150, 0
    v_mov_b32 v151, 0
    v_mov_b32 v152, 0
    v_mov_b32 v153, 0
    v_mov_b32 v154, 0
    v_mov_b32 v155, 0
    v_mov_b32 v156, 0
    v_mov_b32 v157, 0
    v_mov_b32 v158, 0
    v_mov_b32 v159, 0
    v_mov_b32 v160, 0
    v_mov_b32 v161, 0
    v_mov_b32 v162, 0
    v_mov_b32 v163, 0
    v_mov_b32 v164, 0
    v_mov_b32 v165, 0
    v_mov_b32 v166, 0
    v_mov_b32 v167, 0
    v_mov_b32 v168, 0
    v_mov_b32 v169, 0
    v_mov_b32 v170, 0
    v_mov_b32 v171, 0
    v_mov_b32 v172, 0
    v_mov_b32 v173, 0
    v_mov_b32 v174, 0
    v_mov_b32 v175, 0
    v_mov_b32 v176, 0
    v_mov_b32 v177, 0
    v_mov_b32 v178, 0
    v_mov_b32 v179, 0
    v_mov_b32 v180, 0
    v_mov_b32 v181, 0
    v_mov_b32 v182, 0
    v_mov_b32 v183, 0
    v_mov_b32 v184, 0
    v_mov_b32 v185, 0
    v_mov_b32 v186, 0
    v_mov_b32 v187, 0
    v_mov_b32 v188, 0
    v_mov_b32 v189, 0
    v_mov_b32 v190, 0
    v_mov_b32 v191, 0
    v_mov_b32 v192, 0
    v_mov_b32 v193, 0
    v_mov_b32 v194, 0
    v_mov_b32 v195, 0
    v_mov_b32 v196, 0
    v_mov_b32 v197, 0
    v_mov_b32 v198, 0
    v_mov_b32 v199, 0
    v_mov_b32 v200, 0
    v_mov_b32 v201, 0
    v_mov_b32 v202, 0
    v_mov_b32 v203, 0
    v_mov_b32 v204, 0
    v_mov_b32 v205, 0
    v_mov_b32 v206, 0
    v_mov_b32 v207, 0
    v_mov_b32 v208, 0
    v_mov_b32 v209, 0
    v_mov_b32 v210, 0
    v_mov_b32 v211, 0
    v_mov_b32 v212, 0
    v_mov_b32 v213, 0
    v_mov_b32 v214, 0
    v_mov_b32 v215, 0
    v_mov_b32 v216, 0
    v_mov_b32 v217, 0
    v_mov_b32 v218, 0
    v_mov_b32 v219, 0
    s_waitcnt vmcnt(0)
    v_lshlrev_b32 v224, 16, v8
    v_and_b32 v225, 0xffff0000, v8
    v_lshlrev_b32 v226, 16, v9
    v_and_b32 v227, 0xffff0000, v9
    v_lshlrev_b32 v228, 16, v10
    v_and_b32 v229, 0xffff0000, v10
    v_lshlrev_b32 v230, 16, v11
    v_and_b32 v231, 0xffff0000, v11
    v_add_f32 v48, v48, v50
    v_add_f32 v49, v49, v51
    v_add_f32 v48, v48, v52
    v_add_f32 v49, v49, v53
    v_add_f32 v48, v48, v54
    v_add_f32 v49, v49, v55
    v_add_f32 v48, v48, v56
    v_add_f32 v49, v49, v57
    v_add_f32 v48, v48, v58
    v_add_f32 v49, v49, v59
    v_add_f32 v48, v48, v60
    v_add_f32 v49, v49, v61
    v_add_f32 v48, v48, v62
    v_add_f32 v49, v49, v63
    s_nop 1
    v_add_f32_dpp v48, v48, v48 quad_perm:[1,0,3,2] row_mask:0xf bank_mask:0xf
    v_add_f32_dpp v49, v49, v49 quad_perm:[1,0,3,2] row_mask:0xf bank_mask:0xf
    v_mul_f32 v48, 0x3a800000, v48
    v_mul_f32 v49, 0x3a800000, v49
    v_fma_f32 v49, -v48, v48, v49
    v_max_f32 v49, 0, v49
    v_add_f32 v51, 0x3727c5ac, v49
    v_rcp_f32 v50, v51
    s_nop 0
    v_mul_f32 v52, v49, v50
    v_add_f32 v52, 0x3727c5ac, v52
    v_mul_f32 v52, v52, v51
    v_sqrt_f32 v52, v52
    s_nop 0
    v_rcp_f32 v49, v52
    s_nop 0
    ds_write_b64 v64, v[48:49]

    s_waitcnt lgkmcnt(0)
    s_barrier
    ds_read_b128 v[8:11], v96 offset:0
    ds_read_b128 v[12:15], v96 offset:2048
    ds_read_b128 v[16:19], v96 offset:4096
    ds_read_b128 v[20:23], v96 offset:6144
    ds_read_b64_tr_b16 v[40:41], v98 offset:0
    ds_read_b64_tr_b16 v[42:43], v98 offset:512
    ds_read_b64_tr_b16 v[44:45], v99 offset:0
    ds_read_b64_tr_b16 v[46:47], v99 offset:512
    ds_read_b64_tr_b16 v[48:49], v100 offset:0
    ds_read_b64_tr_b16 v[50:51], v100 offset:512
    ds_read_b64_tr_b16 v[52:53], v101 offset:0
    ds_read_b64_tr_b16 v[54:55], v101 offset:512
    ds_read_b64_tr_b16 v[56:57], v102 offset:0
    ds_read_b64_tr_b16 v[58:59], v102 offset:512
    ds_read_b64_tr_b16 v[60:61], v103 offset:0
    ds_read_b64_tr_b16 v[62:63], v103 offset:512
    ds_read_b64_tr_b16 v[64:65], v104 offset:0
    ds_read_b64_tr_b16 v[66:67], v104 offset:512
    s_mov_b32 s28, 0
    s_mov_b32 s29, 0
w1_kernel_cloop:
    s_waitcnt lgkmcnt(0)
    v_mfma_f32_16x16x32_bf16 v[108:111], v[40:43], v[8:11], v[108:111]
    ds_read_b128 v[24:27], v97 offset:0
    v_mfma_f32_16x16x32_bf16 v[112:115], v[40:43], v[12:15], v[112:115]
    ds_read_b128 v[28:31], v97 offset:2048
    v_mfma_f32_16x16x32_bf16 v[116:119], v[40:43], v[16:19], v[116:119]
    ds_read_b128 v[32:35], v97 offset:4096
    v_mfma_f32_16x16x32_bf16 v[120:123], v[40:43], v[20:23], v[120:123]
    ds_read_b128 v[36:39], v97 offset:6144
    v_mfma_f32_16x16x32_bf16 v[124:127], v[44:47], v[8:11], v[124:127]
    ds_read_b64_tr_b16 v[68:69], v98 offset:4096
    v_mfma_f32_16x16x32_bf16 v[128:131], v[44:47], v[12:15], v[128:131]
    ds_read_b64_tr_b16 v[70:71], v98 offset:4608
    v_mfma_f32_16x16x32_bf16 v[132:135], v[44:47], v[16:19], v[132:135]
    ds_read_b64_tr_b16 v[72:73], v99 offset:4096
    v_mfma_f32_16x16x32_bf16 v[136:139], v[44:47], v[20:23], v[136:139]
    ds_read_b64_tr_b16 v[74:75], v99 offset:4608
    v_mfma_f32_16x16x32_bf16 v[140:143], v[48:51], v[8:11], v[140:143]
    ds_read_b64_tr_b16 v[76:77], v100 offset:4096
    v_mfma_f32_16x16x32_bf16 v[144:147], v[48:51], v[12:15], v[144:147]
    ds_read_b64_tr_b16 v[78:79], v100 offset:4608
    v_mfma_f32_16x16x32_bf16 v[148:151], v[48:51], v[16:19], v[148:151]
    ds_read_b64_tr_b16 v[80:81], v101 offset:4096
    v_mfma_f32_16x16x32_bf16 v[152:155], v[48:51], v[20:23], v[152:155]
    ds_read_b64_tr_b16 v[82:83], v101 offset:4608
    v_mfma_f32_16x16x32_bf16 v[156:159], v[52:55], v[8:11], v[156:159]
    ds_read_b64_tr_b16 v[84:85], v102 offset:4096
    v_mfma_f32_16x16x32_bf16 v[160:163], v[52:55], v[12:15], v[160:163]
    ds_read_b64_tr_b16 v[86:87], v102 offset:4608
    v_mfma_f32_16x16x32_bf16 v[164:167], v[52:55], v[16:19], v[164:167]
    ds_read_b64_tr_b16 v[88:89], v103 offset:4096
    v_mfma_f32_16x16x32_bf16 v[168:171], v[52:55], v[20:23], v[168:171]
    ds_read_b64_tr_b16 v[90:91], v103 offset:4608
    v_mfma_f32_16x16x32_bf16 v[172:175], v[56:59], v[8:11], v[172:175]
    ds_read_b64_tr_b16 v[92:93], v104 offset:4096
    v_mfma_f32_16x16x32_bf16 v[176:179], v[56:59], v[12:15], v[176:179]
    ds_read_b64_tr_b16 v[94:95], v104 offset:4608
    v_mfma_f32_16x16x32_bf16 v[180:183], v[56:59], v[16:19], v[180:183]
    s_add_u32 s29, s29, 1
    s_cmp_eq_u32 s29, 3
    v_mfma_f32_16x16x32_bf16 v[184:187], v[56:59], v[20:23], v[184:187]
    s_cselect_b32 s27, 4294868992, s40
    s_cselect_b32 s29, 0, s29
    v_mfma_f32_16x16x32_bf16 v[188:191], v[60:63], v[8:11], v[188:191]
    s_add_u32 s28, s28, 1
    v_add_u32 v96, s27, v96
    v_mfma_f32_16x16x32_bf16 v[192:195], v[60:63], v[12:15], v[192:195]
    v_add_u32 v97, s27, v97
    v_add_u32 v98, s27, v98
    v_mfma_f32_16x16x32_bf16 v[196:199], v[60:63], v[16:19], v[196:199]
    v_add_u32 v99, s27, v99
    v_add_u32 v100, s27, v100
    v_mfma_f32_16x16x32_bf16 v[200:203], v[60:63], v[20:23], v[200:203]
    v_add_u32 v101, s27, v101
    v_add_u32 v102, s27, v102
    v_mfma_f32_16x16x32_bf16 v[204:207], v[64:67], v[8:11], v[204:207]
    v_add_u32 v103, s27, v103
    v_add_u32 v104, s27, v104
    v_mfma_f32_16x16x32_bf16 v[208:211], v[64:67], v[12:15], v[208:211]
    v_mfma_f32_16x16x32_bf16 v[212:215], v[64:67], v[16:19], v[212:215]
    v_mfma_f32_16x16x32_bf16 v[216:219], v[64:67], v[20:23], v[216:219]
    s_waitcnt lgkmcnt(0)
    s_cmp_eq_u32 s28, 16
    s_cbranch_scc1 w1_kernel_clast
    s_barrier

    s_cmp_eq_u32 s28, 3
    s_cbranch_scc1 w1_kernel_pf0
w1_kernel_pfdone0:
    v_mfma_f32_16x16x32_bf16 v[108:111], v[68:71], v[24:27], v[108:111]
    ds_read_b128 v[8:11], v96 offset:0
    v_mfma_f32_16x16x32_bf16 v[112:115], v[68:71], v[28:31], v[112:115]
    ds_read_b128 v[12:15], v96 offset:2048
    v_mfma_f32_16x16x32_bf16 v[116:119], v[68:71], v[32:35], v[116:119]
    ds_read_b128 v[16:19], v96 offset:4096
    v_mfma_f32_16x16x32_bf16 v[120:123], v[68:71], v[36:39], v[120:123]
    ds_read_b128 v[20:23], v96 offset:6144
    v_mfma_f32_16x16x32_bf16 v[124:127], v[72:75], v[24:27], v[124:127]
    ds_read_b64_tr_b16 v[40:41], v98 offset:0
    v_mfma_f32_16x16x32_bf16 v[128:131], v[72:75], v[28:31], v[128:131]
    ds_read_b64_tr_b16 v[42:43], v98 offset:512
    v_mfma_f32_16x16x32_bf16 v[132:135], v[72:75], v[32:35], v[132:135]
    ds_read_b64_tr_b16 v[44:45], v99 offset:0
    v_mfma_f32_16x16x32_bf16 v[136:139], v[72:75], v[36:39], v[136:139]
    ds_read_b64_tr_b16 v[46:47], v99 offset:512
    v_mfma_f32_16x16x32_bf16 v[140:143], v[76:79], v[24:27], v[140:143]
    ds_read_b64_tr_b16 v[48:49], v100 offset:0
    v_mfma_f32_16x16x32_bf16 v[144:147], v[76:79], v[28:31], v[144:147]
    ds_read_b64_tr_b16 v[50:51], v100 offset:512
    v_mfma_f32_16x16x32_bf16 v[148:151], v[76:79], v[32:35], v[148:151]
    ds_read_b64_tr_b16 v[52:53], v101 offset:0
    v_mfma_f32_16x16x32_bf16 v[152:155], v[76:79], v[36:39], v[152:155]
    ds_read_b64_tr_b16 v[54:55], v101 offset:512
    v_mfma_f32_16x16x32_bf16 v[156:159], v[80:83], v[24:27], v[156:159]
    ds_read_b64_tr_b16 v[56:57], v102 offset:0
    v_mfma_f32_16x16x32_bf16 v[160:163], v[80:83], v[28:31], v[160:163]
    ds_read_b64_tr_b16 v[58:59], v102 offset:512
    v_mfma_f32_16x16x32_bf16 v[164:167], v[80:83], v[32:35], v[164:167]
    ds_read_b64_tr_b16 v[60:61], v103 offset:0
    v_mfma_f32_16x16x32_bf16 v[168:171], v[80:83], v[36:39], v[168:171]
    ds_read_b64_tr_b16 v[62:63], v103 offset:512
    v_mfma_f32_16x16x32_bf16 v[172:175], v[84:87], v[24:27], v[172:175]
    ds_read_b64_tr_b16 v[64:65], v104 offset:0
    v_mfma_f32_16x16x32_bf16 v[176:179], v[84:87], v[28:31], v[176:179]
    ds_read_b64_tr_b16 v[66:67], v104 offset:512
    v_mfma_f32_16x16x32_bf16 v[180:183], v[84:87], v[32:35], v[180:183]
    v_mfma_f32_16x16x32_bf16 v[184:187], v[84:87], v[36:39], v[184:187]
    v_mfma_f32_16x16x32_bf16 v[188:191], v[88:91], v[24:27], v[188:191]
    v_mfma_f32_16x16x32_bf16 v[192:195], v[88:91], v[28:31], v[192:195]
    v_mfma_f32_16x16x32_bf16 v[196:199], v[88:91], v[32:35], v[196:199]
    v_mfma_f32_16x16x32_bf16 v[200:203], v[88:91], v[36:39], v[200:203]
    v_mfma_f32_16x16x32_bf16 v[204:207], v[92:95], v[24:27], v[204:207]
    v_mfma_f32_16x16x32_bf16 v[208:211], v[92:95], v[28:31], v[208:211]
    v_mfma_f32_16x16x32_bf16 v[212:215], v[92:95], v[32:35], v[212:215]
    v_mfma_f32_16x16x32_bf16 v[216:219], v[92:95], v[36:39], v[216:219]
    s_branch w1_kernel_cloop
w1_kernel_pf0:
    s_lshl_b32 s32, s2, 2
    s_add_u32 s32, s32, s26
    s_mul_i32 s32, s32, 7168
    v_lshlrev_b32 v1, 4, v0
    v_add_u32 v1, s32, v1
    v_add_u32 v2, 4096, v1

    buffer_load_dwordx4 v[240:243], v1, s[52:55], 0 offen offset:0
    buffer_load_dwordx4 v[240:243], v1, s[52:55], 0 offen offset:1024
    buffer_load_dwordx4 v[240:243], v1, s[52:55], 0 offen offset:2048
    buffer_load_dwordx4 v[240:243], v1, s[52:55], 0 offen offset:3072
    buffer_load_dwordx4 v[240:243], v2, s[52:55], 0 offen offset:0
    buffer_load_dwordx4 v[240:243], v2, s[52:55], 0 offen offset:1024
    buffer_load_dwordx4 v[240:243], v2, s[52:55], 0 offen offset:2048
    s_branch w1_kernel_pfdone0
w1_kernel_clast:
    v_mfma_f32_16x16x32_bf16 v[108:111], v[68:71], v[24:27], v[108:111]
    v_mfma_f32_16x16x32_bf16 v[112:115], v[68:71], v[28:31], v[112:115]
    v_mfma_f32_16x16x32_bf16 v[116:119], v[68:71], v[32:35], v[116:119]
    v_mfma_f32_16x16x32_bf16 v[120:123], v[68:71], v[36:39], v[120:123]
    v_mfma_f32_16x16x32_bf16 v[124:127], v[72:75], v[24:27], v[124:127]
    v_mfma_f32_16x16x32_bf16 v[128:131], v[72:75], v[28:31], v[128:131]
    v_mfma_f32_16x16x32_bf16 v[132:135], v[72:75], v[32:35], v[132:135]
    v_mfma_f32_16x16x32_bf16 v[136:139], v[72:75], v[36:39], v[136:139]
    v_mfma_f32_16x16x32_bf16 v[140:143], v[76:79], v[24:27], v[140:143]
    v_mfma_f32_16x16x32_bf16 v[144:147], v[76:79], v[28:31], v[144:147]
    v_mfma_f32_16x16x32_bf16 v[148:151], v[76:79], v[32:35], v[148:151]
    v_mfma_f32_16x16x32_bf16 v[152:155], v[76:79], v[36:39], v[152:155]
    v_mfma_f32_16x16x32_bf16 v[156:159], v[80:83], v[24:27], v[156:159]
    v_mfma_f32_16x16x32_bf16 v[160:163], v[80:83], v[28:31], v[160:163]
    v_mfma_f32_16x16x32_bf16 v[164:167], v[80:83], v[32:35], v[164:167]
    v_mfma_f32_16x16x32_bf16 v[168:171], v[80:83], v[36:39], v[168:171]
    v_mfma_f32_16x16x32_bf16 v[172:175], v[84:87], v[24:27], v[172:175]
    v_mfma_f32_16x16x32_bf16 v[176:179], v[84:87], v[28:31], v[176:179]
    v_mfma_f32_16x16x32_bf16 v[180:183], v[84:87], v[32:35], v[180:183]
    v_mfma_f32_16x16x32_bf16 v[184:187], v[84:87], v[36:39], v[184:187]
    v_mfma_f32_16x16x32_bf16 v[188:191], v[88:91], v[24:27], v[188:191]
    v_mfma_f32_16x16x32_bf16 v[192:195], v[88:91], v[28:31], v[192:195]
    v_mfma_f32_16x16x32_bf16 v[196:199], v[88:91], v[32:35], v[196:199]
    v_mfma_f32_16x16x32_bf16 v[200:203], v[88:91], v[36:39], v[200:203]
    v_mfma_f32_16x16x32_bf16 v[204:207], v[92:95], v[24:27], v[204:207]
    v_mfma_f32_16x16x32_bf16 v[208:211], v[92:95], v[28:31], v[208:211]
    v_mfma_f32_16x16x32_bf16 v[212:215], v[92:95], v[32:35], v[212:215]
    v_mfma_f32_16x16x32_bf16 v[216:219], v[92:95], v[36:39], v[216:219]
    v_and_b32 v1, 15, v0
    v_lshrrev_b32 v2, 4, v0
    s_lshl_b32 s32, s30, 6
    v_add_u32 v1, s32, v1
    s_mov_b32 s33, 912
    v_mul_lo_u32 v1, v1, s33
    s_mul_i32 s34, s31, 448
    v_lshlrev_b32 v2, 4, v2
    v_add3_u32 v1, v1, v2, s34

    s_barrier
    ds_write_b128 v1, v[108:111] offset:0
    ds_write_b128 v1, v[124:127] offset:64
    ds_write_b128 v1, v[140:143] offset:128
    ds_write_b128 v1, v[156:159] offset:192
    ds_write_b128 v1, v[172:175] offset:256
    ds_write_b128 v1, v[188:191] offset:320
    ds_write_b128 v1, v[204:207] offset:384
    ds_write_b128 v1, v[112:115] offset:14592
    ds_write_b128 v1, v[128:131] offset:14656
    ds_write_b128 v1, v[144:147] offset:14720
    ds_write_b128 v1, v[160:163] offset:14784
    ds_write_b128 v1, v[176:179] offset:14848
    ds_write_b128 v1, v[192:195] offset:14912
    ds_write_b128 v1, v[208:211] offset:14976
    ds_write_b128 v1, v[116:119] offset:29184
    ds_write_b128 v1, v[132:135] offset:29248
    ds_write_b128 v1, v[148:151] offset:29312
    ds_write_b128 v1, v[164:167] offset:29376
    ds_write_b128 v1, v[180:183] offset:29440
    ds_write_b128 v1, v[196:199] offset:29504
    ds_write_b128 v1, v[212:215] offset:29568
    ds_write_b128 v1, v[120:123] offset:43776
    ds_write_b128 v1, v[136:139] offset:43840
    ds_write_b128 v1, v[152:155] offset:43904
    ds_write_b128 v1, v[168:171] offset:43968
    ds_write_b128 v1, v[184:187] offset:44032
    ds_write_b128 v1, v[200:203] offset:44096
    ds_write_b128 v1, v[216:219] offset:44160
    s_waitcnt lgkmcnt(0)
    s_branch w1_kernel_epi2
w1_kernel_prod:
    v_mov_b32 v51, v5
    s_sub_u32 s27, s26, 4
    v_lshrrev_b32 v1, 3, v0
    v_and_b32 v2, 7, v0
    v_lshrrev_b32 v3, 4, v0
    s_and_b32 s34, s27, 1
    s_lshl_b32 s35, s34, 2

    v_xor_b32 v4, v2, v3
    v_xor_b32 v4, s35, v4
    s_lshl_b32 s36, s27, 3
    s_add_u32 s37, s36, s24
    v_add_u32 v5, s37, v1
    s_mov_b32 s38, 2048
    v_mul_lo_u32 v5, v5, s38
    v_lshl_add_u32 v48, v4, 4, v5

    v_and_b32 v4, 1, v3
    s_lshl_b32 s35, s34, 1
    v_or_b32 v4, s35, v4
    v_lshlrev_b32 v4, 1, v4
    v_xor_b32 v4, v4, v2
    v_add_u32 v5, s36, v1
    s_mov_b32 s38, 7168
    v_mul_lo_u32 v5, v5, s38
    s_lshl_b32 s39, s25, 1
    s_and_b32 s39, s39, 0xffffff80
    v_add_u32 v5, s39, v5
    v_lshl_add_u32 v49, v4, 4, v5

    v_cmp_gt_u32 vcc, 4, v4
    v_mov_b32 v6, 0x7ff00000
    s_bitcmp1_b32 s25, 5
    s_cselect_b64 s[36:37], -1, 0
    s_or_b64 s[34:35], vcc, s[36:37]
    s_nand_b64 s[36:37], vcc, s[36:37]
    v_cndmask_b32 v50, v6, v49, s[34:35]
    v_cndmask_b32 v52, v6, v49, s[36:37]

    s_mul_i32 s28, s41, 2048
    s_mul_i32 s29, s41, 7340032
    s_lshl_b32 s30, s27, 10
    s_mov_b32 s33, 0

    s_add_u32 m0, s30, 0
    s_add_u32 s31, s28, 0
    buffer_load_dwordx4 v48, s[4:7], s31 offen lds
    s_add_u32 m0, s30, 4096
    s_add_u32 s31, s28, 65536
    buffer_load_dwordx4 v48, s[4:7], s31 offen lds
    s_add_u32 m0, s30, 8192
    s_add_u32 s31, s28, 131072
    buffer_load_dwordx4 v48, s[4:7], s31 offen lds
    s_add_u32 m0, s30, 12288
    s_add_u32 s31, s28, 196608
    buffer_load_dwordx4 v48, s[4:7], s31 offen lds
    s_add_u32 m0, s30, 16384
    s_add_u32 s31, s29, 0
    buffer_load_dwordx4 v52, s[8:11], s31 offen lds
    s_add_u32 m0, s30, 20480
    s_add_u32 s31, s29, 229376
    buffer_load_dwordx4 v52, s[8:11], s31 offen lds
    s_add_u32 m0, s30, 24576
    s_add_u32 s31, s29, 128
    buffer_load_dwordx4 v49, s[8:11], s31 offen lds
    s_add_u32 m0, s30, 28672
    s_add_u32 s31, s29, 229504
    buffer_load_dwordx4 v49, s[8:11], s31 offen lds
    s_add_u32 m0, s30, 32768
    s_add_u32 s31, s29, 256
    buffer_load_dwordx4 v49, s[8:11], s31 offen lds
    s_add_u32 m0, s30, 36864
    s_add_u32 s31, s29, 229632
    buffer_load_dwordx4 v49, s[8:11], s31 offen lds
    s_add_u32 m0, s30, 40960
    s_add_u32 s31, s29, 384
    buffer_load_dwordx4 v50, s[8:11], s31 offen lds
    s_add_u32 m0, s30, 45056
    s_add_u32 s31, s29, 229760
    buffer_load_dwordx4 v50, s[8:11], s31 offen lds
    s_add_u32 s28, s28, 128
    s_add_u32 s29, s29, 458752
    s_add_u32 s33, s33, 1
    s_cmp_eq_u32 s33, 3
    s_cselect_b32 s31, 4294868992, s40
    s_cselect_b32 s33, 0, s33
    s_add_u32 s30, s30, s31

    s_add_u32 m0, s30, 0
    s_add_u32 s31, s28, 0
    buffer_load_dwordx4 v48, s[4:7], s31 offen lds
    s_add_u32 m0, s30, 4096
    s_add_u32 s31, s28, 65536
    buffer_load_dwordx4 v48, s[4:7], s31 offen lds
    s_add_u32 m0, s30, 8192
    s_add_u32 s31, s28, 131072
    buffer_load_dwordx4 v48, s[4:7], s31 offen lds
    s_add_u32 m0, s30, 12288
    s_add_u32 s31, s28, 196608
    buffer_load_dwordx4 v48, s[4:7], s31 offen lds
    s_add_u32 m0, s30, 16384
    s_add_u32 s31, s29, 0
    buffer_load_dwordx4 v52, s[8:11], s31 offen lds
    s_add_u32 m0, s30, 20480
    s_add_u32 s31, s29, 229376
    buffer_load_dwordx4 v52, s[8:11], s31 offen lds
    s_add_u32 m0, s30, 24576
    s_add_u32 s31, s29, 128
    buffer_load_dwordx4 v49, s[8:11], s31 offen lds
    s_add_u32 m0, s30, 28672
    s_add_u32 s31, s29, 229504
    buffer_load_dwordx4 v49, s[8:11], s31 offen lds
    s_add_u32 m0, s30, 32768
    s_add_u32 s31, s29, 256
    buffer_load_dwordx4 v49, s[8:11], s31 offen lds
    s_add_u32 m0, s30, 36864
    s_add_u32 s31, s29, 229632
    buffer_load_dwordx4 v49, s[8:11], s31 offen lds
    s_add_u32 m0, s30, 40960
    s_add_u32 s31, s29, 384
    buffer_load_dwordx4 v50, s[8:11], s31 offen lds
    s_add_u32 m0, s30, 45056
    s_add_u32 s31, s29, 229760
    buffer_load_dwordx4 v50, s[8:11], s31 offen lds
    s_add_u32 s28, s28, 128
    s_add_u32 s29, s29, 458752
    s_add_u32 s33, s33, 1
    s_cmp_eq_u32 s33, 3
    s_cselect_b32 s31, 4294868992, s40
    s_cselect_b32 s33, 0, s33
    s_add_u32 s30, s30, s31

    s_waitcnt vmcnt(12)
    s_barrier
    s_mov_b32 s32, 0
w1_kernel_ploop:
    s_cmp_ge_u32 s32, 14
    s_cbranch_scc1 w1_kernel_pnoissue
    s_add_u32 m0, s30, 0
    s_add_u32 s31, s28, 0
    buffer_load_dwordx4 v48, s[4:7], s31 offen lds
    s_add_u32 m0, s30, 4096
    s_add_u32 s31, s28, 65536
    buffer_load_dwordx4 v48, s[4:7], s31 offen lds
    s_add_u32 m0, s30, 8192
    s_add_u32 s31, s28, 131072
    buffer_load_dwordx4 v48, s[4:7], s31 offen lds
    s_add_u32 m0, s30, 12288
    s_add_u32 s31, s28, 196608
    buffer_load_dwordx4 v48, s[4:7], s31 offen lds
    s_add_u32 m0, s30, 16384
    s_add_u32 s31, s29, 0
    buffer_load_dwordx4 v52, s[8:11], s31 offen lds
    s_add_u32 m0, s30, 20480
    s_add_u32 s31, s29, 229376
    buffer_load_dwordx4 v52, s[8:11], s31 offen lds
    s_add_u32 m0, s30, 24576
    s_add_u32 s31, s29, 128
    buffer_load_dwordx4 v49, s[8:11], s31 offen lds
    s_add_u32 m0, s30, 28672
    s_add_u32 s31, s29, 229504
    buffer_load_dwordx4 v49, s[8:11], s31 offen lds
    s_add_u32 m0, s30, 32768
    s_add_u32 s31, s29, 256
    buffer_load_dwordx4 v49, s[8:11], s31 offen lds
    s_add_u32 m0, s30, 36864
    s_add_u32 s31, s29, 229632
    buffer_load_dwordx4 v49, s[8:11], s31 offen lds
    s_add_u32 m0, s30, 40960
    s_add_u32 s31, s29, 384
    buffer_load_dwordx4 v50, s[8:11], s31 offen lds
    s_add_u32 m0, s30, 45056
    s_add_u32 s31, s29, 229760
    buffer_load_dwordx4 v50, s[8:11], s31 offen lds
    s_add_u32 s28, s28, 128
    s_add_u32 s29, s29, 458752
    s_add_u32 s33, s33, 1
    s_cmp_eq_u32 s33, 3
    s_cselect_b32 s31, 4294868992, s40
    s_cselect_b32 s33, 0, s33
    s_add_u32 s30, s30, s31

    s_waitcnt vmcnt(12)
    s_branch w1_kernel_pbar
w1_kernel_pnoissue:
    s_waitcnt vmcnt(0)
    s_cmp_lg_u32 s32, 14
    s_cbranch_scc1 w1_kernel_pbar
    s_lshl_b32 s34, s27, 6
    v_add_u32 v64, s34, v0
    v_add_u32 v65, s25, v64
    v_lshlrev_b32 v65, 2, v65

    s_mov_b32 s35, 0
    buffer_load_dword v68, v65, s[48:51], s35 offen
    s_mov_b32 s35, 14336
    buffer_load_dword v69, v65, s[48:51], s35 offen
    s_mov_b32 s35, 28672
    buffer_load_dword v70, v65, s[48:51], s35 offen
    s_mov_b32 s35, 43008
    buffer_load_dword v71, v65, s[48:51], s35 offen
    s_mov_b32 s35, 57344
    buffer_load_dword v72, v65, s[48:51], s35 offen
    s_mov_b32 s35, 71680
    buffer_load_dword v73, v65, s[48:51], s35 offen
    s_mov_b32 s35, 86016
    buffer_load_dword v74, v65, s[48:51], s35 offen
    s_mov_b32 s35, 100352
    buffer_load_dword v75, v65, s[48:51], s35 offen
    s_mov_b32 s35, 114688
    buffer_load_dword v76, v65, s[48:51], s35 offen
    s_mov_b32 s35, 129024
    buffer_load_dword v77, v65, s[48:51], s35 offen
    s_mov_b32 s35, 143360
    buffer_load_dword v78, v65, s[48:51], s35 offen
    s_mov_b32 s35, 157696
    buffer_load_dword v79, v65, s[48:51], s35 offen
    s_mov_b32 s35, 172032
    buffer_load_dword v80, v65, s[48:51], s35 offen
    s_mov_b32 s35, 186368
    buffer_load_dword v81, v65, s[48:51], s35 offen
    s_mov_b32 s35, 200704
    buffer_load_dword v82, v65, s[48:51], s35 offen
    s_mov_b32 s35, 215040
    buffer_load_dword v83, v65, s[48:51], s35 offen
w1_kernel_pbar:
    s_barrier
    s_add_u32 s32, s32, 1
    s_cmp_lt_u32 s32, 15
    s_cbranch_scc1 w1_kernel_ploop
    v_mov_b32 v5, v51
    buffer_load_dwordx4 v[8:11], v5, s[20:23], 0 offen
    s_waitcnt vmcnt(0)
    v_lshlrev_b32 v224, 16, v8
    v_and_b32 v225, 0xffff0000, v8
    v_lshlrev_b32 v226, 16, v9
    v_and_b32 v227, 0xffff0000, v9
    v_lshlrev_b32 v228, 16, v10
    v_and_b32 v229, 0xffff0000, v10
    v_lshlrev_b32 v230, 16, v11
    v_and_b32 v231, 0xffff0000, v11
    v_add_f32 v68, v68, v69
    v_add_f32 v70, v70, v71
    v_add_f32 v72, v72, v73
    v_add_f32 v74, v74, v75
    v_add_f32 v76, v76, v77
    v_add_f32 v78, v78, v79
    v_add_f32 v80, v80, v81
    v_add_f32 v82, v82, v83
    v_add_f32 v68, v68, v70
    v_add_f32 v72, v72, v74
    v_add_f32 v76, v76, v78
    v_add_f32 v80, v80, v82
    v_add_f32 v68, v68, v72
    v_add_f32 v76, v76, v80
    v_add_f32 v68, v68, v76
    v_lshlrev_b32 v65, 2, v64
    v_lshlrev_b32 v66, 3, v64
    v_add_u32 v65, 116736, v65
    v_add_u32 v66, 147456, v66

    s_barrier
    ds_write_b32 v65, v68
    s_waitcnt lgkmcnt(0)
w1_kernel_epi2:
    s_barrier
    v_lshlrev_b32 v1, 5, v223
    v_add_u32 v1, 116736, v1
    ds_read_b128 v[232:235], v1
    ds_read_b128 v[236:239], v1 offset:16
    v_cmp_gt_u32 vcc, 56, v0
    s_and_b64 exec, exec, vcc

    s_mov_b32 s36, 0xc0135761
    s_mov_b32 s37, 0xc0135761
    s_mov_b32 s38, 0xbdd2d3e8
    s_mov_b32 s39, 0xbdd2d3e8
    v_mov_b32 v60, s36
    v_mov_b32 v61, s36
    v_mov_b32 v62, 1.0
    v_mov_b32 v63, 1.0
    ds_read_b128 v[8:11], v220 offset:0
    ds_read_b128 v[12:15], v220 offset:16
    ds_read_b64 v[56:57], v222 offset:0
    ds_read_b128 v[24:27], v220 offset:1824
    ds_read_b128 v[28:31], v220 offset:1840
    ds_read_b64 v[58:59], v222 offset:16
    s_waitcnt lgkmcnt(3)
    v_pk_fma_f32 v[8:9], v[56:57], v[232:233], v[8:9] op_sel_hi:[0,1,1] neg_lo:[1,0,0] neg_hi:[1,0,0]
    v_pk_fma_f32 v[10:11], v[56:57], v[234:235], v[10:11] op_sel_hi:[0,1,1] neg_lo:[1,0,0] neg_hi:[1,0,0]
    v_pk_fma_f32 v[12:13], v[56:57], v[236:237], v[12:13] op_sel_hi:[0,1,1] neg_lo:[1,0,0] neg_hi:[1,0,0]
    v_pk_fma_f32 v[14:15], v[56:57], v[238:239], v[14:15] op_sel_hi:[0,1,1] neg_lo:[1,0,0] neg_hi:[1,0,0]
    v_pk_fma_f32 v[8:9], v[8:9], v[56:57], v[224:225] op_sel:[0,1,0] op_sel_hi:[1,1,1]
    v_pk_fma_f32 v[10:11], v[10:11], v[56:57], v[226:227] op_sel:[0,1,0] op_sel_hi:[1,1,1]
    v_pk_fma_f32 v[12:13], v[12:13], v[56:57], v[228:229] op_sel:[0,1,0] op_sel_hi:[1,1,1]
    v_pk_fma_f32 v[14:15], v[14:15], v[56:57], v[230:231] op_sel:[0,1,0] op_sel_hi:[1,1,1]
    v_pk_mul_f32 v[16:17], v[8:9], v[8:9]
    v_pk_mul_f32 v[18:19], v[10:11], v[10:11]
    v_pk_mul_f32 v[20:21], v[12:13], v[12:13]
    v_pk_mul_f32 v[22:23], v[14:15], v[14:15]
    v_pk_fma_f32 v[16:17], v[16:17], s[38:39], v[60:61]
    v_pk_fma_f32 v[18:19], v[18:19], s[38:39], v[60:61]
    v_pk_fma_f32 v[20:21], v[20:21], s[38:39], v[60:61]
    v_pk_fma_f32 v[22:23], v[22:23], s[38:39], v[60:61]
    v_pk_mul_f32 v[16:17], v[16:17], v[8:9]
    v_pk_mul_f32 v[18:19], v[18:19], v[10:11]
    v_pk_mul_f32 v[20:21], v[20:21], v[12:13]
    v_pk_mul_f32 v[22:23], v[22:23], v[14:15]
    v_exp_f32 v16, v16
    v_exp_f32 v17, v17
    v_exp_f32 v18, v18
    v_exp_f32 v19, v19
    v_exp_f32 v20, v20
    v_exp_f32 v21, v21
    v_exp_f32 v22, v22
    v_exp_f32 v23, v23
    v_pk_add_f32 v[16:17], v[16:17], v[62:63]
    v_pk_add_f32 v[18:19], v[18:19], v[62:63]
    v_pk_add_f32 v[20:21], v[20:21], v[62:63]
    v_pk_add_f32 v[22:23], v[22:23], v[62:63]
    v_rcp_f32 v16, v16
    v_rcp_f32 v17, v17
    v_rcp_f32 v18, v18
    v_rcp_f32 v19, v19
    v_rcp_f32 v20, v20
    v_rcp_f32 v21, v21
    v_rcp_f32 v22, v22
    v_rcp_f32 v23, v23
    v_pk_mul_f32 v[8:9], v[8:9], v[16:17]
    v_pk_mul_f32 v[10:11], v[10:11], v[18:19]
    v_pk_mul_f32 v[12:13], v[12:13], v[20:21]
    v_pk_mul_f32 v[14:15], v[14:15], v[22:23]
    v_cvt_pk_bf16_f32 v16, v8, v9
    v_cvt_pk_bf16_f32 v17, v10, v11
    v_cvt_pk_bf16_f32 v18, v12, v13
    v_cvt_pk_bf16_f32 v19, v14, v15
    s_mov_b32 s35, 0
    buffer_store_dwordx4 v[16:19], v221, s[12:15], s35 offen sc1
    ds_read_b128 v[8:11], v220 offset:3648
    ds_read_b128 v[12:15], v220 offset:3664
    ds_read_b64 v[56:57], v222 offset:32
    s_waitcnt lgkmcnt(3)
    v_pk_fma_f32 v[24:25], v[58:59], v[232:233], v[24:25] op_sel_hi:[0,1,1] neg_lo:[1,0,0] neg_hi:[1,0,0]
    v_pk_fma_f32 v[26:27], v[58:59], v[234:235], v[26:27] op_sel_hi:[0,1,1] neg_lo:[1,0,0] neg_hi:[1,0,0]
    v_pk_fma_f32 v[28:29], v[58:59], v[236:237], v[28:29] op_sel_hi:[0,1,1] neg_lo:[1,0,0] neg_hi:[1,0,0]
    v_pk_fma_f32 v[30:31], v[58:59], v[238:239], v[30:31] op_sel_hi:[0,1,1] neg_lo:[1,0,0] neg_hi:[1,0,0]
    v_pk_fma_f32 v[24:25], v[24:25], v[58:59], v[224:225] op_sel:[0,1,0] op_sel_hi:[1,1,1]
    v_pk_fma_f32 v[26:27], v[26:27], v[58:59], v[226:227] op_sel:[0,1,0] op_sel_hi:[1,1,1]
    v_pk_fma_f32 v[28:29], v[28:29], v[58:59], v[228:229] op_sel:[0,1,0] op_sel_hi:[1,1,1]
    v_pk_fma_f32 v[30:31], v[30:31], v[58:59], v[230:231] op_sel:[0,1,0] op_sel_hi:[1,1,1]
    v_pk_mul_f32 v[32:33], v[24:25], v[24:25]
    v_pk_mul_f32 v[34:35], v[26:27], v[26:27]
    v_pk_mul_f32 v[36:37], v[28:29], v[28:29]
    v_pk_mul_f32 v[38:39], v[30:31], v[30:31]
    v_pk_fma_f32 v[32:33], v[32:33], s[38:39], v[60:61]
    v_pk_fma_f32 v[34:35], v[34:35], s[38:39], v[60:61]
    v_pk_fma_f32 v[36:37], v[36:37], s[38:39], v[60:61]
    v_pk_fma_f32 v[38:39], v[38:39], s[38:39], v[60:61]
    v_pk_mul_f32 v[32:33], v[32:33], v[24:25]
    v_pk_mul_f32 v[34:35], v[34:35], v[26:27]
    v_pk_mul_f32 v[36:37], v[36:37], v[28:29]
    v_pk_mul_f32 v[38:39], v[38:39], v[30:31]
    v_exp_f32 v32, v32
    v_exp_f32 v33, v33
    v_exp_f32 v34, v34
    v_exp_f32 v35, v35
    v_exp_f32 v36, v36
    v_exp_f32 v37, v37
    v_exp_f32 v38, v38
    v_exp_f32 v39, v39
    v_pk_add_f32 v[32:33], v[32:33], v[62:63]
    v_pk_add_f32 v[34:35], v[34:35], v[62:63]
    v_pk_add_f32 v[36:37], v[36:37], v[62:63]
    v_pk_add_f32 v[38:39], v[38:39], v[62:63]
    v_rcp_f32 v32, v32
    v_rcp_f32 v33, v33
    v_rcp_f32 v34, v34
    v_rcp_f32 v35, v35
    v_rcp_f32 v36, v36
    v_rcp_f32 v37, v37
    v_rcp_f32 v38, v38
    v_rcp_f32 v39, v39
    v_pk_mul_f32 v[24:25], v[24:25], v[32:33]
    v_pk_mul_f32 v[26:27], v[26:27], v[34:35]
    v_pk_mul_f32 v[28:29], v[28:29], v[36:37]
    v_pk_mul_f32 v[30:31], v[30:31], v[38:39]
    v_cvt_pk_bf16_f32 v32, v24, v25
    v_cvt_pk_bf16_f32 v33, v26, v27
    v_cvt_pk_bf16_f32 v34, v28, v29
    v_cvt_pk_bf16_f32 v35, v30, v31
    s_mov_b32 s35, 14336
    buffer_store_dwordx4 v[32:35], v221, s[12:15], s35 offen sc1
    ds_read_b128 v[24:27], v220 offset:5472
    ds_read_b128 v[28:31], v220 offset:5488
    ds_read_b64 v[58:59], v222 offset:48
    s_waitcnt lgkmcnt(3)
    v_pk_fma_f32 v[8:9], v[56:57], v[232:233], v[8:9] op_sel_hi:[0,1,1] neg_lo:[1,0,0] neg_hi:[1,0,0]
    v_pk_fma_f32 v[10:11], v[56:57], v[234:235], v[10:11] op_sel_hi:[0,1,1] neg_lo:[1,0,0] neg_hi:[1,0,0]
    v_pk_fma_f32 v[12:13], v[56:57], v[236:237], v[12:13] op_sel_hi:[0,1,1] neg_lo:[1,0,0] neg_hi:[1,0,0]
    v_pk_fma_f32 v[14:15], v[56:57], v[238:239], v[14:15] op_sel_hi:[0,1,1] neg_lo:[1,0,0] neg_hi:[1,0,0]
    v_pk_fma_f32 v[8:9], v[8:9], v[56:57], v[224:225] op_sel:[0,1,0] op_sel_hi:[1,1,1]
    v_pk_fma_f32 v[10:11], v[10:11], v[56:57], v[226:227] op_sel:[0,1,0] op_sel_hi:[1,1,1]
    v_pk_fma_f32 v[12:13], v[12:13], v[56:57], v[228:229] op_sel:[0,1,0] op_sel_hi:[1,1,1]
    v_pk_fma_f32 v[14:15], v[14:15], v[56:57], v[230:231] op_sel:[0,1,0] op_sel_hi:[1,1,1]
    v_pk_mul_f32 v[16:17], v[8:9], v[8:9]
    v_pk_mul_f32 v[18:19], v[10:11], v[10:11]
    v_pk_mul_f32 v[20:21], v[12:13], v[12:13]
    v_pk_mul_f32 v[22:23], v[14:15], v[14:15]
    v_pk_fma_f32 v[16:17], v[16:17], s[38:39], v[60:61]
    v_pk_fma_f32 v[18:19], v[18:19], s[38:39], v[60:61]
    v_pk_fma_f32 v[20:21], v[20:21], s[38:39], v[60:61]
    v_pk_fma_f32 v[22:23], v[22:23], s[38:39], v[60:61]
    v_pk_mul_f32 v[16:17], v[16:17], v[8:9]
    v_pk_mul_f32 v[18:19], v[18:19], v[10:11]
    v_pk_mul_f32 v[20:21], v[20:21], v[12:13]
    v_pk_mul_f32 v[22:23], v[22:23], v[14:15]
    v_exp_f32 v16, v16
    v_exp_f32 v17, v17
    v_exp_f32 v18, v18
    v_exp_f32 v19, v19
    v_exp_f32 v20, v20
    v_exp_f32 v21, v21
    v_exp_f32 v22, v22
    v_exp_f32 v23, v23
    v_pk_add_f32 v[16:17], v[16:17], v[62:63]
    v_pk_add_f32 v[18:19], v[18:19], v[62:63]
    v_pk_add_f32 v[20:21], v[20:21], v[62:63]
    v_pk_add_f32 v[22:23], v[22:23], v[62:63]
    v_rcp_f32 v16, v16
    v_rcp_f32 v17, v17
    v_rcp_f32 v18, v18
    v_rcp_f32 v19, v19
    v_rcp_f32 v20, v20
    v_rcp_f32 v21, v21
    v_rcp_f32 v22, v22
    v_rcp_f32 v23, v23
    v_pk_mul_f32 v[8:9], v[8:9], v[16:17]
    v_pk_mul_f32 v[10:11], v[10:11], v[18:19]
    v_pk_mul_f32 v[12:13], v[12:13], v[20:21]
    v_pk_mul_f32 v[14:15], v[14:15], v[22:23]
    v_cvt_pk_bf16_f32 v16, v8, v9
    v_cvt_pk_bf16_f32 v17, v10, v11
    v_cvt_pk_bf16_f32 v18, v12, v13
    v_cvt_pk_bf16_f32 v19, v14, v15
    s_mov_b32 s35, 28672
    buffer_store_dwordx4 v[16:19], v221, s[12:15], s35 offen sc1
    ds_read_b128 v[8:11], v220 offset:7296
    ds_read_b128 v[12:15], v220 offset:7312
    ds_read_b64 v[56:57], v222 offset:64
    s_waitcnt lgkmcnt(3)
    v_pk_fma_f32 v[24:25], v[58:59], v[232:233], v[24:25] op_sel_hi:[0,1,1] neg_lo:[1,0,0] neg_hi:[1,0,0]
    v_pk_fma_f32 v[26:27], v[58:59], v[234:235], v[26:27] op_sel_hi:[0,1,1] neg_lo:[1,0,0] neg_hi:[1,0,0]
    v_pk_fma_f32 v[28:29], v[58:59], v[236:237], v[28:29] op_sel_hi:[0,1,1] neg_lo:[1,0,0] neg_hi:[1,0,0]
    v_pk_fma_f32 v[30:31], v[58:59], v[238:239], v[30:31] op_sel_hi:[0,1,1] neg_lo:[1,0,0] neg_hi:[1,0,0]
    v_pk_fma_f32 v[24:25], v[24:25], v[58:59], v[224:225] op_sel:[0,1,0] op_sel_hi:[1,1,1]
    v_pk_fma_f32 v[26:27], v[26:27], v[58:59], v[226:227] op_sel:[0,1,0] op_sel_hi:[1,1,1]
    v_pk_fma_f32 v[28:29], v[28:29], v[58:59], v[228:229] op_sel:[0,1,0] op_sel_hi:[1,1,1]
    v_pk_fma_f32 v[30:31], v[30:31], v[58:59], v[230:231] op_sel:[0,1,0] op_sel_hi:[1,1,1]
    v_pk_mul_f32 v[32:33], v[24:25], v[24:25]
    v_pk_mul_f32 v[34:35], v[26:27], v[26:27]
    v_pk_mul_f32 v[36:37], v[28:29], v[28:29]
    v_pk_mul_f32 v[38:39], v[30:31], v[30:31]
    v_pk_fma_f32 v[32:33], v[32:33], s[38:39], v[60:61]
    v_pk_fma_f32 v[34:35], v[34:35], s[38:39], v[60:61]
    v_pk_fma_f32 v[36:37], v[36:37], s[38:39], v[60:61]
    v_pk_fma_f32 v[38:39], v[38:39], s[38:39], v[60:61]
    v_pk_mul_f32 v[32:33], v[32:33], v[24:25]
    v_pk_mul_f32 v[34:35], v[34:35], v[26:27]
    v_pk_mul_f32 v[36:37], v[36:37], v[28:29]
    v_pk_mul_f32 v[38:39], v[38:39], v[30:31]
    v_exp_f32 v32, v32
    v_exp_f32 v33, v33
    v_exp_f32 v34, v34
    v_exp_f32 v35, v35
    v_exp_f32 v36, v36
    v_exp_f32 v37, v37
    v_exp_f32 v38, v38
    v_exp_f32 v39, v39
    v_pk_add_f32 v[32:33], v[32:33], v[62:63]
    v_pk_add_f32 v[34:35], v[34:35], v[62:63]
    v_pk_add_f32 v[36:37], v[36:37], v[62:63]
    v_pk_add_f32 v[38:39], v[38:39], v[62:63]
    v_rcp_f32 v32, v32
    v_rcp_f32 v33, v33
    v_rcp_f32 v34, v34
    v_rcp_f32 v35, v35
    v_rcp_f32 v36, v36
    v_rcp_f32 v37, v37
    v_rcp_f32 v38, v38
    v_rcp_f32 v39, v39
    v_pk_mul_f32 v[24:25], v[24:25], v[32:33]
    v_pk_mul_f32 v[26:27], v[26:27], v[34:35]
    v_pk_mul_f32 v[28:29], v[28:29], v[36:37]
    v_pk_mul_f32 v[30:31], v[30:31], v[38:39]
    v_cvt_pk_bf16_f32 v32, v24, v25
    v_cvt_pk_bf16_f32 v33, v26, v27
    v_cvt_pk_bf16_f32 v34, v28, v29
    v_cvt_pk_bf16_f32 v35, v30, v31
    s_mov_b32 s35, 43008
    buffer_store_dwordx4 v[32:35], v221, s[12:15], s35 offen sc1
    ds_read_b128 v[24:27], v220 offset:9120
    ds_read_b128 v[28:31], v220 offset:9136
    ds_read_b64 v[58:59], v222 offset:80
    s_waitcnt lgkmcnt(3)
    v_pk_fma_f32 v[8:9], v[56:57], v[232:233], v[8:9] op_sel_hi:[0,1,1] neg_lo:[1,0,0] neg_hi:[1,0,0]
    v_pk_fma_f32 v[10:11], v[56:57], v[234:235], v[10:11] op_sel_hi:[0,1,1] neg_lo:[1,0,0] neg_hi:[1,0,0]
    v_pk_fma_f32 v[12:13], v[56:57], v[236:237], v[12:13] op_sel_hi:[0,1,1] neg_lo:[1,0,0] neg_hi:[1,0,0]
    v_pk_fma_f32 v[14:15], v[56:57], v[238:239], v[14:15] op_sel_hi:[0,1,1] neg_lo:[1,0,0] neg_hi:[1,0,0]
    v_pk_fma_f32 v[8:9], v[8:9], v[56:57], v[224:225] op_sel:[0,1,0] op_sel_hi:[1,1,1]
    v_pk_fma_f32 v[10:11], v[10:11], v[56:57], v[226:227] op_sel:[0,1,0] op_sel_hi:[1,1,1]
    v_pk_fma_f32 v[12:13], v[12:13], v[56:57], v[228:229] op_sel:[0,1,0] op_sel_hi:[1,1,1]
    v_pk_fma_f32 v[14:15], v[14:15], v[56:57], v[230:231] op_sel:[0,1,0] op_sel_hi:[1,1,1]
    v_pk_mul_f32 v[16:17], v[8:9], v[8:9]
    v_pk_mul_f32 v[18:19], v[10:11], v[10:11]
    v_pk_mul_f32 v[20:21], v[12:13], v[12:13]
    v_pk_mul_f32 v[22:23], v[14:15], v[14:15]
    v_pk_fma_f32 v[16:17], v[16:17], s[38:39], v[60:61]
    v_pk_fma_f32 v[18:19], v[18:19], s[38:39], v[60:61]
    v_pk_fma_f32 v[20:21], v[20:21], s[38:39], v[60:61]
    v_pk_fma_f32 v[22:23], v[22:23], s[38:39], v[60:61]
    v_pk_mul_f32 v[16:17], v[16:17], v[8:9]
    v_pk_mul_f32 v[18:19], v[18:19], v[10:11]
    v_pk_mul_f32 v[20:21], v[20:21], v[12:13]
    v_pk_mul_f32 v[22:23], v[22:23], v[14:15]
    v_exp_f32 v16, v16
    v_exp_f32 v17, v17
    v_exp_f32 v18, v18
    v_exp_f32 v19, v19
    v_exp_f32 v20, v20
    v_exp_f32 v21, v21
    v_exp_f32 v22, v22
    v_exp_f32 v23, v23
    v_pk_add_f32 v[16:17], v[16:17], v[62:63]
    v_pk_add_f32 v[18:19], v[18:19], v[62:63]
    v_pk_add_f32 v[20:21], v[20:21], v[62:63]
    v_pk_add_f32 v[22:23], v[22:23], v[62:63]
    v_rcp_f32 v16, v16
    v_rcp_f32 v17, v17
    v_rcp_f32 v18, v18
    v_rcp_f32 v19, v19
    v_rcp_f32 v20, v20
    v_rcp_f32 v21, v21
    v_rcp_f32 v22, v22
    v_rcp_f32 v23, v23
    v_pk_mul_f32 v[8:9], v[8:9], v[16:17]
    v_pk_mul_f32 v[10:11], v[10:11], v[18:19]
    v_pk_mul_f32 v[12:13], v[12:13], v[20:21]
    v_pk_mul_f32 v[14:15], v[14:15], v[22:23]
    v_cvt_pk_bf16_f32 v16, v8, v9
    v_cvt_pk_bf16_f32 v17, v10, v11
    v_cvt_pk_bf16_f32 v18, v12, v13
    v_cvt_pk_bf16_f32 v19, v14, v15
    s_mov_b32 s35, 57344
    buffer_store_dwordx4 v[16:19], v221, s[12:15], s35 offen sc1
    ds_read_b128 v[8:11], v220 offset:10944
    ds_read_b128 v[12:15], v220 offset:10960
    ds_read_b64 v[56:57], v222 offset:96
    s_waitcnt lgkmcnt(3)
    v_pk_fma_f32 v[24:25], v[58:59], v[232:233], v[24:25] op_sel_hi:[0,1,1] neg_lo:[1,0,0] neg_hi:[1,0,0]
    v_pk_fma_f32 v[26:27], v[58:59], v[234:235], v[26:27] op_sel_hi:[0,1,1] neg_lo:[1,0,0] neg_hi:[1,0,0]
    v_pk_fma_f32 v[28:29], v[58:59], v[236:237], v[28:29] op_sel_hi:[0,1,1] neg_lo:[1,0,0] neg_hi:[1,0,0]
    v_pk_fma_f32 v[30:31], v[58:59], v[238:239], v[30:31] op_sel_hi:[0,1,1] neg_lo:[1,0,0] neg_hi:[1,0,0]
    v_pk_fma_f32 v[24:25], v[24:25], v[58:59], v[224:225] op_sel:[0,1,0] op_sel_hi:[1,1,1]
    v_pk_fma_f32 v[26:27], v[26:27], v[58:59], v[226:227] op_sel:[0,1,0] op_sel_hi:[1,1,1]
    v_pk_fma_f32 v[28:29], v[28:29], v[58:59], v[228:229] op_sel:[0,1,0] op_sel_hi:[1,1,1]
    v_pk_fma_f32 v[30:31], v[30:31], v[58:59], v[230:231] op_sel:[0,1,0] op_sel_hi:[1,1,1]
    v_pk_mul_f32 v[32:33], v[24:25], v[24:25]
    v_pk_mul_f32 v[34:35], v[26:27], v[26:27]
    v_pk_mul_f32 v[36:37], v[28:29], v[28:29]
    v_pk_mul_f32 v[38:39], v[30:31], v[30:31]
    v_pk_fma_f32 v[32:33], v[32:33], s[38:39], v[60:61]
    v_pk_fma_f32 v[34:35], v[34:35], s[38:39], v[60:61]
    v_pk_fma_f32 v[36:37], v[36:37], s[38:39], v[60:61]
    v_pk_fma_f32 v[38:39], v[38:39], s[38:39], v[60:61]
    v_pk_mul_f32 v[32:33], v[32:33], v[24:25]
    v_pk_mul_f32 v[34:35], v[34:35], v[26:27]
    v_pk_mul_f32 v[36:37], v[36:37], v[28:29]
    v_pk_mul_f32 v[38:39], v[38:39], v[30:31]
    v_exp_f32 v32, v32
    v_exp_f32 v33, v33
    v_exp_f32 v34, v34
    v_exp_f32 v35, v35
    v_exp_f32 v36, v36
    v_exp_f32 v37, v37
    v_exp_f32 v38, v38
    v_exp_f32 v39, v39
    v_pk_add_f32 v[32:33], v[32:33], v[62:63]
    v_pk_add_f32 v[34:35], v[34:35], v[62:63]
    v_pk_add_f32 v[36:37], v[36:37], v[62:63]
    v_pk_add_f32 v[38:39], v[38:39], v[62:63]
    v_rcp_f32 v32, v32
    v_rcp_f32 v33, v33
    v_rcp_f32 v34, v34
    v_rcp_f32 v35, v35
    v_rcp_f32 v36, v36
    v_rcp_f32 v37, v37
    v_rcp_f32 v38, v38
    v_rcp_f32 v39, v39
    v_pk_mul_f32 v[24:25], v[24:25], v[32:33]
    v_pk_mul_f32 v[26:27], v[26:27], v[34:35]
    v_pk_mul_f32 v[28:29], v[28:29], v[36:37]
    v_pk_mul_f32 v[30:31], v[30:31], v[38:39]
    v_cvt_pk_bf16_f32 v32, v24, v25
    v_cvt_pk_bf16_f32 v33, v26, v27
    v_cvt_pk_bf16_f32 v34, v28, v29
    v_cvt_pk_bf16_f32 v35, v30, v31
    s_mov_b32 s35, 71680
    buffer_store_dwordx4 v[32:35], v221, s[12:15], s35 offen sc1
    ds_read_b128 v[24:27], v220 offset:12768
    ds_read_b128 v[28:31], v220 offset:12784
    ds_read_b64 v[58:59], v222 offset:112
    s_waitcnt lgkmcnt(3)
    v_pk_fma_f32 v[8:9], v[56:57], v[232:233], v[8:9] op_sel_hi:[0,1,1] neg_lo:[1,0,0] neg_hi:[1,0,0]
    v_pk_fma_f32 v[10:11], v[56:57], v[234:235], v[10:11] op_sel_hi:[0,1,1] neg_lo:[1,0,0] neg_hi:[1,0,0]
    v_pk_fma_f32 v[12:13], v[56:57], v[236:237], v[12:13] op_sel_hi:[0,1,1] neg_lo:[1,0,0] neg_hi:[1,0,0]
    v_pk_fma_f32 v[14:15], v[56:57], v[238:239], v[14:15] op_sel_hi:[0,1,1] neg_lo:[1,0,0] neg_hi:[1,0,0]
    v_pk_fma_f32 v[8:9], v[8:9], v[56:57], v[224:225] op_sel:[0,1,0] op_sel_hi:[1,1,1]
    v_pk_fma_f32 v[10:11], v[10:11], v[56:57], v[226:227] op_sel:[0,1,0] op_sel_hi:[1,1,1]
    v_pk_fma_f32 v[12:13], v[12:13], v[56:57], v[228:229] op_sel:[0,1,0] op_sel_hi:[1,1,1]
    v_pk_fma_f32 v[14:15], v[14:15], v[56:57], v[230:231] op_sel:[0,1,0] op_sel_hi:[1,1,1]
    v_pk_mul_f32 v[16:17], v[8:9], v[8:9]
    v_pk_mul_f32 v[18:19], v[10:11], v[10:11]
    v_pk_mul_f32 v[20:21], v[12:13], v[12:13]
    v_pk_mul_f32 v[22:23], v[14:15], v[14:15]
    v_pk_fma_f32 v[16:17], v[16:17], s[38:39], v[60:61]
    v_pk_fma_f32 v[18:19], v[18:19], s[38:39], v[60:61]
    v_pk_fma_f32 v[20:21], v[20:21], s[38:39], v[60:61]
    v_pk_fma_f32 v[22:23], v[22:23], s[38:39], v[60:61]
    v_pk_mul_f32 v[16:17], v[16:17], v[8:9]
    v_pk_mul_f32 v[18:19], v[18:19], v[10:11]
    v_pk_mul_f32 v[20:21], v[20:21], v[12:13]
    v_pk_mul_f32 v[22:23], v[22:23], v[14:15]
    v_exp_f32 v16, v16
    v_exp_f32 v17, v17
    v_exp_f32 v18, v18
    v_exp_f32 v19, v19
    v_exp_f32 v20, v20
    v_exp_f32 v21, v21
    v_exp_f32 v22, v22
    v_exp_f32 v23, v23
    v_pk_add_f32 v[16:17], v[16:17], v[62:63]
    v_pk_add_f32 v[18:19], v[18:19], v[62:63]
    v_pk_add_f32 v[20:21], v[20:21], v[62:63]
    v_pk_add_f32 v[22:23], v[22:23], v[62:63]
    v_rcp_f32 v16, v16
    v_rcp_f32 v17, v17
    v_rcp_f32 v18, v18
    v_rcp_f32 v19, v19
    v_rcp_f32 v20, v20
    v_rcp_f32 v21, v21
    v_rcp_f32 v22, v22
    v_rcp_f32 v23, v23
    v_pk_mul_f32 v[8:9], v[8:9], v[16:17]
    v_pk_mul_f32 v[10:11], v[10:11], v[18:19]
    v_pk_mul_f32 v[12:13], v[12:13], v[20:21]
    v_pk_mul_f32 v[14:15], v[14:15], v[22:23]
    v_cvt_pk_bf16_f32 v16, v8, v9
    v_cvt_pk_bf16_f32 v17, v10, v11
    v_cvt_pk_bf16_f32 v18, v12, v13
    v_cvt_pk_bf16_f32 v19, v14, v15
    s_mov_b32 s35, 86016
    buffer_store_dwordx4 v[16:19], v221, s[12:15], s35 offen sc1
    s_waitcnt lgkmcnt(0)
    v_pk_fma_f32 v[24:25], v[58:59], v[232:233], v[24:25] op_sel_hi:[0,1,1] neg_lo:[1,0,0] neg_hi:[1,0,0]
    v_pk_fma_f32 v[26:27], v[58:59], v[234:235], v[26:27] op_sel_hi:[0,1,1] neg_lo:[1,0,0] neg_hi:[1,0,0]
    v_pk_fma_f32 v[28:29], v[58:59], v[236:237], v[28:29] op_sel_hi:[0,1,1] neg_lo:[1,0,0] neg_hi:[1,0,0]
    v_pk_fma_f32 v[30:31], v[58:59], v[238:239], v[30:31] op_sel_hi:[0,1,1] neg_lo:[1,0,0] neg_hi:[1,0,0]
    v_pk_fma_f32 v[24:25], v[24:25], v[58:59], v[224:225] op_sel:[0,1,0] op_sel_hi:[1,1,1]
    v_pk_fma_f32 v[26:27], v[26:27], v[58:59], v[226:227] op_sel:[0,1,0] op_sel_hi:[1,1,1]
    v_pk_fma_f32 v[28:29], v[28:29], v[58:59], v[228:229] op_sel:[0,1,0] op_sel_hi:[1,1,1]
    v_pk_fma_f32 v[30:31], v[30:31], v[58:59], v[230:231] op_sel:[0,1,0] op_sel_hi:[1,1,1]
    v_pk_mul_f32 v[32:33], v[24:25], v[24:25]
    v_pk_mul_f32 v[34:35], v[26:27], v[26:27]
    v_pk_mul_f32 v[36:37], v[28:29], v[28:29]
    v_pk_mul_f32 v[38:39], v[30:31], v[30:31]
    v_pk_fma_f32 v[32:33], v[32:33], s[38:39], v[60:61]
    v_pk_fma_f32 v[34:35], v[34:35], s[38:39], v[60:61]
    v_pk_fma_f32 v[36:37], v[36:37], s[38:39], v[60:61]
    v_pk_fma_f32 v[38:39], v[38:39], s[38:39], v[60:61]
    v_pk_mul_f32 v[32:33], v[32:33], v[24:25]
    v_pk_mul_f32 v[34:35], v[34:35], v[26:27]
    v_pk_mul_f32 v[36:37], v[36:37], v[28:29]
    v_pk_mul_f32 v[38:39], v[38:39], v[30:31]
    v_exp_f32 v32, v32
    v_exp_f32 v33, v33
    v_exp_f32 v34, v34
    v_exp_f32 v35, v35
    v_exp_f32 v36, v36
    v_exp_f32 v37, v37
    v_exp_f32 v38, v38
    v_exp_f32 v39, v39
    v_pk_add_f32 v[32:33], v[32:33], v[62:63]
    v_pk_add_f32 v[34:35], v[34:35], v[62:63]
    v_pk_add_f32 v[36:37], v[36:37], v[62:63]
    v_pk_add_f32 v[38:39], v[38:39], v[62:63]
    v_rcp_f32 v32, v32
    v_rcp_f32 v33, v33
    v_rcp_f32 v34, v34
    v_rcp_f32 v35, v35
    v_rcp_f32 v36, v36
    v_rcp_f32 v37, v37
    v_rcp_f32 v38, v38
    v_rcp_f32 v39, v39
    v_pk_mul_f32 v[24:25], v[24:25], v[32:33]
    v_pk_mul_f32 v[26:27], v[26:27], v[34:35]
    v_pk_mul_f32 v[28:29], v[28:29], v[36:37]
    v_pk_mul_f32 v[30:31], v[30:31], v[38:39]
    v_cvt_pk_bf16_f32 v32, v24, v25
    v_cvt_pk_bf16_f32 v33, v26, v27
    v_cvt_pk_bf16_f32 v34, v28, v29
    v_cvt_pk_bf16_f32 v35, v30, v31
    s_mov_b32 s35, 100352
    buffer_store_dwordx4 v[32:35], v221, s[12:15], s35 offen sc1
w1_kernel_end:
    s_endpgm
.globl w2_kernel
.p2align 8
.type w2_kernel,@function
w2_kernel:
    s_cmp_ge_u32 s2, 256
    s_cbranch_scc1 w2_kernel_end
    s_load_dwordx2 s[4:5], s[0:1], 80
    s_load_dwordx2 s[8:9], s[0:1], 48
    s_load_dwordx2 s[12:13], s[0:1], 64
    s_load_dwordx2 s[16:17], s[0:1], 80
    s_load_dwordx2 s[20:21], s[0:1], 56
    s_and_b32 s27, s2, 7
    s_lshr_b32 s28, s2, 3
    s_and_b32 s29, s27, 1
    s_lshl_b32 s29, s29, 3
    s_and_b32 s30, s28, 7
    s_add_u32 s29, s29, s30
    s_lshr_b32 s30, s27, 1
    s_lshl_b32 s30, s30, 2
    s_lshr_b32 s31, s28, 3
    s_add_u32 s30, s30, s31
    s_mov_b32 s41, 0

    s_lshl_b32 s24, s29, 7
    s_mul_i32 s25, s30, 64
    v_lshrrev_b32 v1, 6, v0
    v_and_b32 v0, 63, v0
    s_mov_b32 s40, 24576
    v_readfirstlane_b32 s26, v1

    v_lshrrev_b32 v1, 3, v0
    v_and_b32 v95, 7, v0
    s_lshl_b32 s32, s26, 4
    v_add_u32 v1, s32, v1
    s_mul_i32 s34, s41, 64
    s_add_u32 s33, s25, s34
    s_mov_b32 s35, 272
    v_mul_lo_u32 v92, v1, s35
    v_lshl_add_u32 v92, v95, 5, v92
    s_lshl_b32 s34, s34, 2
    v_add_u32 v92, s34, v92
    v_add_u32 v2, s24, v1
    v_lshlrev_b32 v5, 4, v95
    s_lshl_b32 s34, s33, 1
    v_add_u32 v5, s34, v5

    s_mov_b32 s35, 2048
    v_mul_lo_u32 v93, v2, s35
    v_add_u32 v93, v93, v5

    s_waitcnt lgkmcnt(0)
    s_add_u32 s4, s4, 29360128
    s_addc_u32 s5, s5, 0
    s_and_b32 s5, s5, 0xffff
    s_mov_b32 s6, 14680064
    s_mov_b32 s7, 0x00020000
    s_and_b32 s9, s9, 0xffff
    s_mov_b32 s10, 7340032
    s_mov_b32 s11, 0x00020000
    s_and_b32 s13, s13, 0xffff
    s_mov_b32 s14, 4194304
    s_mov_b32 s15, 0x00020000
    s_add_u32 s16, s16, 20971520
    s_addc_u32 s17, s17, 0
    s_and_b32 s17, s17, 0xffff
    s_mov_b32 s18, 4194304
    s_mov_b32 s19, 0x00020000
    s_and_b32 s21, s21, 0xffff
    s_mov_b32 s22, 2048
    s_mov_b32 s23, 0x00020000
    s_cmp_ge_u32 s26, 4
    s_cbranch_scc1 w2_kernel_prod
    buffer_load_dwordx4 v[8:11], v5, s[20:23], 0 offen
    s_mov_b32 s35, 0
    buffer_load_dwordx4 v[104:107], v93, s[16:19], s35 offen
    s_mov_b32 s35, 16384
    buffer_load_dwordx4 v[108:111], v93, s[16:19], s35 offen
    s_and_b32 s30, s26, 1
    s_lshr_b32 s31, s26, 1
    v_and_b32 v1, 15, v0
    v_lshrrev_b32 v2, 4, v0

    v_lshrrev_b32 v3, 1, v1
    v_xor_b32 v3, v3, v2
    v_lshlrev_b32 v3, 4, v3
    s_lshl_b32 s32, s30, 13
    v_lshlrev_b32 v4, 7, v1
    v_add_u32 v4, s32, v4
    v_add_u32 v56, v4, v3
    v_xor_b32 v57, 64, v56

    v_lshrrev_b32 v3, 2, v1
    v_lshrrev_b32 v4, 1, v3
    v_and_b32 v5, 1, v2
    v_lshlrev_b32 v5, 1, v5
    v_or_b32 v4, v4, v5
    v_lshlrev_b32 v5, 3, v2
    v_add_u32 v5, v5, v3
    v_lshlrev_b32 v5, 7, v5
    v_and_b32 v6, 3, v0
    v_lshlrev_b32 v6, 3, v6
    v_add_u32 v5, v5, v6
    v_add_u32 v5, 16384, v5
    s_mul_i32 s32, s31, 2

    s_add_u32 s33, s32, 0
    s_lshr_b32 s34, s33, 2
    s_lshl_b32 s34, s34, 13
    s_and_b32 s33, s33, 3
    v_xor_b32 v6, s33, v4
    v_lshlrev_b32 v6, 5, v6
    v_add_u32 v6, s34, v6
    v_add_u32 v58, v6, v5

    s_add_u32 s33, s32, 1
    s_lshr_b32 s34, s33, 2
    s_lshl_b32 s34, s34, 13
    s_and_b32 s33, s33, 3
    v_xor_b32 v6, s33, v4
    v_lshlrev_b32 v6, 5, v6
    v_add_u32 v6, s34, v6
    v_add_u32 v59, v6, v5

    v_mov_b32 v60, 0
    v_mov_b32 v61, 0
    v_mov_b32 v62, 0
    v_mov_b32 v63, 0
    v_mov_b32 v64, 0
    v_mov_b32 v65, 0
    v_mov_b32 v66, 0
    v_mov_b32 v67, 0
    v_mov_b32 v68, 0
    v_mov_b32 v69, 0
    v_mov_b32 v70, 0
    v_mov_b32 v71, 0
    v_mov_b32 v72, 0
    v_mov_b32 v73, 0
    v_mov_b32 v74, 0
    v_mov_b32 v75, 0
    v_mov_b32 v76, 0
    v_mov_b32 v77, 0
    v_mov_b32 v78, 0
    v_mov_b32 v79, 0
    v_mov_b32 v80, 0
    v_mov_b32 v81, 0
    v_mov_b32 v82, 0
    v_mov_b32 v83, 0
    v_mov_b32 v84, 0
    v_mov_b32 v85, 0
    v_mov_b32 v86, 0
    v_mov_b32 v87, 0
    v_mov_b32 v88, 0
    v_mov_b32 v89, 0
    v_mov_b32 v90, 0
    v_mov_b32 v91, 0
    s_waitcnt vmcnt(2)
    v_lshlrev_b32 v96, 16, v8
    v_and_b32 v97, 0xffff0000, v8
    v_lshlrev_b32 v98, 16, v9
    v_and_b32 v99, 0xffff0000, v9
    v_lshlrev_b32 v100, 16, v10
    v_and_b32 v101, 0xffff0000, v10
    v_lshlrev_b32 v102, 16, v11
    v_and_b32 v103, 0xffff0000, v11
    s_barrier
    ds_read_b128 v[8:11], v56 offset:0
    ds_read_b128 v[12:15], v56 offset:2048
    ds_read_b128 v[16:19], v56 offset:4096
    ds_read_b128 v[20:23], v56 offset:6144
    ds_read_b64_tr_b16 v[40:41], v58 offset:0
    ds_read_b64_tr_b16 v[42:43], v58 offset:512
    ds_read_b64_tr_b16 v[44:45], v59 offset:0
    ds_read_b64_tr_b16 v[46:47], v59 offset:512
    s_mov_b32 s28, 0
    s_mov_b32 s29, 0
w2_kernel_cloop:
    s_waitcnt lgkmcnt(0)
    v_mfma_f32_16x16x32_bf16 v[60:63], v[40:43], v[8:11], v[60:63]
    ds_read_b128 v[24:27], v57 offset:0
    v_mfma_f32_16x16x32_bf16 v[64:67], v[40:43], v[12:15], v[64:67]
    ds_read_b128 v[28:31], v57 offset:2048
    v_mfma_f32_16x16x32_bf16 v[68:71], v[40:43], v[16:19], v[68:71]
    ds_read_b128 v[32:35], v57 offset:4096
    v_mfma_f32_16x16x32_bf16 v[72:75], v[40:43], v[20:23], v[72:75]
    ds_read_b128 v[36:39], v57 offset:6144
    v_mfma_f32_16x16x32_bf16 v[76:79], v[44:47], v[8:11], v[76:79]
    ds_read_b64_tr_b16 v[48:49], v58 offset:4096
    v_mfma_f32_16x16x32_bf16 v[80:83], v[44:47], v[12:15], v[80:83]
    ds_read_b64_tr_b16 v[50:51], v58 offset:4608
    v_mfma_f32_16x16x32_bf16 v[84:87], v[44:47], v[16:19], v[84:87]
    ds_read_b64_tr_b16 v[52:53], v59 offset:4096
    v_mfma_f32_16x16x32_bf16 v[88:91], v[44:47], v[20:23], v[88:91]
    ds_read_b64_tr_b16 v[54:55], v59 offset:4608
    s_add_u32 s29, s29, 1
    s_cmp_eq_u32 s29, 6
    s_cselect_b32 s27, 4294844416, s40
    s_cselect_b32 s29, 0, s29
    s_add_u32 s28, s28, 1
    v_add_u32 v56, s27, v56
    v_add_u32 v57, s27, v57
    v_add_u32 v58, s27, v58
    v_add_u32 v59, s27, v59
    s_waitcnt lgkmcnt(0)
    s_cmp_eq_u32 s28, 56
    s_cbranch_scc1 w2_kernel_clast
    s_barrier

    v_mfma_f32_16x16x32_bf16 v[60:63], v[48:51], v[24:27], v[60:63]
    ds_read_b128 v[8:11], v56 offset:0
    v_mfma_f32_16x16x32_bf16 v[64:67], v[48:51], v[28:31], v[64:67]
    ds_read_b128 v[12:15], v56 offset:2048
    v_mfma_f32_16x16x32_bf16 v[68:71], v[48:51], v[32:35], v[68:71]
    ds_read_b128 v[16:19], v56 offset:4096
    v_mfma_f32_16x16x32_bf16 v[72:75], v[48:51], v[36:39], v[72:75]
    ds_read_b128 v[20:23], v56 offset:6144
    v_mfma_f32_16x16x32_bf16 v[76:79], v[52:55], v[24:27], v[76:79]
    ds_read_b64_tr_b16 v[40:41], v58 offset:0
    v_mfma_f32_16x16x32_bf16 v[80:83], v[52:55], v[28:31], v[80:83]
    ds_read_b64_tr_b16 v[42:43], v58 offset:512
    v_mfma_f32_16x16x32_bf16 v[84:87], v[52:55], v[32:35], v[84:87]
    ds_read_b64_tr_b16 v[44:45], v59 offset:0
    v_mfma_f32_16x16x32_bf16 v[88:91], v[52:55], v[36:39], v[88:91]
    ds_read_b64_tr_b16 v[46:47], v59 offset:512
    s_branch w2_kernel_cloop
w2_kernel_clast:
    v_mfma_f32_16x16x32_bf16 v[60:63], v[48:51], v[24:27], v[60:63]
    v_mfma_f32_16x16x32_bf16 v[64:67], v[48:51], v[28:31], v[64:67]
    v_mfma_f32_16x16x32_bf16 v[68:71], v[48:51], v[32:35], v[68:71]
    v_mfma_f32_16x16x32_bf16 v[72:75], v[48:51], v[36:39], v[72:75]
    v_mfma_f32_16x16x32_bf16 v[76:79], v[52:55], v[24:27], v[76:79]
    v_mfma_f32_16x16x32_bf16 v[80:83], v[52:55], v[28:31], v[80:83]
    v_mfma_f32_16x16x32_bf16 v[84:87], v[52:55], v[32:35], v[84:87]
    v_mfma_f32_16x16x32_bf16 v[88:91], v[52:55], v[36:39], v[88:91]
    v_and_b32 v1, 15, v0
    v_lshrrev_b32 v2, 4, v0
    s_lshl_b32 s32, s30, 6
    v_add_u32 v1, s32, v1
    s_mov_b32 s33, 272
    v_mul_lo_u32 v1, v1, s33
    s_mul_i32 s34, s31, 128
    v_lshlrev_b32 v2, 4, v2
    v_add3_u32 v1, v1, v2, s34

    s_barrier
    ds_write_b128 v1, v[60:63] offset:0
    ds_write_b128 v1, v[76:79] offset:64
    ds_write_b128 v1, v[64:67] offset:4352
    ds_write_b128 v1, v[80:83] offset:4416
    ds_write_b128 v1, v[68:71] offset:8704
    ds_write_b128 v1, v[84:87] offset:8768
    ds_write_b128 v1, v[72:75] offset:13056
    ds_write_b128 v1, v[88:91] offset:13120
    s_waitcnt lgkmcnt(0)
    s_branch w2_kernel_epi2
w2_kernel_prod:
    v_mov_b32 v51, v5
    s_sub_u32 s27, s26, 4
    v_lshrrev_b32 v1, 3, v0
    v_and_b32 v2, 7, v0
    v_lshrrev_b32 v3, 4, v0
    s_and_b32 s34, s27, 1
    s_lshl_b32 s35, s34, 2

    v_xor_b32 v4, v2, v3
    v_xor_b32 v4, s35, v4
    s_lshl_b32 s36, s27, 3
    s_add_u32 s37, s36, s24
    v_add_u32 v5, s37, v1
    s_mov_b32 s38, 7168
    v_mul_lo_u32 v5, v5, s38
    v_lshl_add_u32 v48, v4, 4, v5

    v_and_b32 v4, 1, v3
    s_lshl_b32 s35, s34, 1
    v_or_b32 v4, s35, v4
    v_lshlrev_b32 v4, 1, v4
    v_xor_b32 v4, v4, v2
    v_add_u32 v5, s36, v1
    s_mov_b32 s38, 2048
    v_mul_lo_u32 v5, v5, s38
    s_lshl_b32 s39, s25, 1

    v_add_u32 v5, s39, v5
    v_lshl_add_u32 v49, v4, 4, v5

    s_mul_i32 s28, s41, 7168
    s_mul_i32 s29, s41, 7340032
    s_lshl_b32 s30, s27, 10
    s_mov_b32 s33, 0

    s_add_u32 m0, s30, 0
    s_add_u32 s31, s28, 0
    buffer_load_dwordx4 v48, s[4:7], s31 offen lds
    s_add_u32 m0, s30, 4096
    s_add_u32 s31, s28, 229376
    buffer_load_dwordx4 v48, s[4:7], s31 offen lds
    s_add_u32 m0, s30, 8192
    s_add_u32 s31, s28, 458752
    buffer_load_dwordx4 v48, s[4:7], s31 offen lds
    s_add_u32 m0, s30, 12288
    s_add_u32 s31, s28, 688128
    buffer_load_dwordx4 v48, s[4:7], s31 offen lds
    s_add_u32 m0, s30, 16384
    s_add_u32 s31, s29, 0
    buffer_load_dwordx4 v49, s[8:11], s31 offen lds
    s_add_u32 m0, s30, 20480
    s_add_u32 s31, s29, 65536
    buffer_load_dwordx4 v49, s[8:11], s31 offen lds
    s_add_u32 s28, s28, 128
    s_add_u32 s29, s29, 131072
    s_add_u32 s33, s33, 1
    s_cmp_eq_u32 s33, 6
    s_cselect_b32 s31, 4294844416, s40
    s_cselect_b32 s33, 0, s33
    s_add_u32 s30, s30, s31

    s_add_u32 m0, s30, 0
    s_add_u32 s31, s28, 0
    buffer_load_dwordx4 v48, s[4:7], s31 offen lds
    s_add_u32 m0, s30, 4096
    s_add_u32 s31, s28, 229376
    buffer_load_dwordx4 v48, s[4:7], s31 offen lds
    s_add_u32 m0, s30, 8192
    s_add_u32 s31, s28, 458752
    buffer_load_dwordx4 v48, s[4:7], s31 offen lds
    s_add_u32 m0, s30, 12288
    s_add_u32 s31, s28, 688128
    buffer_load_dwordx4 v48, s[4:7], s31 offen lds
    s_add_u32 m0, s30, 16384
    s_add_u32 s31, s29, 0
    buffer_load_dwordx4 v49, s[8:11], s31 offen lds
    s_add_u32 m0, s30, 20480
    s_add_u32 s31, s29, 65536
    buffer_load_dwordx4 v49, s[8:11], s31 offen lds
    s_add_u32 s28, s28, 128
    s_add_u32 s29, s29, 131072
    s_add_u32 s33, s33, 1
    s_cmp_eq_u32 s33, 6
    s_cselect_b32 s31, 4294844416, s40
    s_cselect_b32 s33, 0, s33
    s_add_u32 s30, s30, s31

    s_add_u32 m0, s30, 0
    s_add_u32 s31, s28, 0
    buffer_load_dwordx4 v48, s[4:7], s31 offen lds
    s_add_u32 m0, s30, 4096
    s_add_u32 s31, s28, 229376
    buffer_load_dwordx4 v48, s[4:7], s31 offen lds
    s_add_u32 m0, s30, 8192
    s_add_u32 s31, s28, 458752
    buffer_load_dwordx4 v48, s[4:7], s31 offen lds
    s_add_u32 m0, s30, 12288
    s_add_u32 s31, s28, 688128
    buffer_load_dwordx4 v48, s[4:7], s31 offen lds
    s_add_u32 m0, s30, 16384
    s_add_u32 s31, s29, 0
    buffer_load_dwordx4 v49, s[8:11], s31 offen lds
    s_add_u32 m0, s30, 20480
    s_add_u32 s31, s29, 65536
    buffer_load_dwordx4 v49, s[8:11], s31 offen lds
    s_add_u32 s28, s28, 128
    s_add_u32 s29, s29, 131072
    s_add_u32 s33, s33, 1
    s_cmp_eq_u32 s33, 6
    s_cselect_b32 s31, 4294844416, s40
    s_cselect_b32 s33, 0, s33
    s_add_u32 s30, s30, s31

    s_add_u32 m0, s30, 0
    s_add_u32 s31, s28, 0
    buffer_load_dwordx4 v48, s[4:7], s31 offen lds
    s_add_u32 m0, s30, 4096
    s_add_u32 s31, s28, 229376
    buffer_load_dwordx4 v48, s[4:7], s31 offen lds
    s_add_u32 m0, s30, 8192
    s_add_u32 s31, s28, 458752
    buffer_load_dwordx4 v48, s[4:7], s31 offen lds
    s_add_u32 m0, s30, 12288
    s_add_u32 s31, s28, 688128
    buffer_load_dwordx4 v48, s[4:7], s31 offen lds
    s_add_u32 m0, s30, 16384
    s_add_u32 s31, s29, 0
    buffer_load_dwordx4 v49, s[8:11], s31 offen lds
    s_add_u32 m0, s30, 20480
    s_add_u32 s31, s29, 65536
    buffer_load_dwordx4 v49, s[8:11], s31 offen lds
    s_add_u32 s28, s28, 128
    s_add_u32 s29, s29, 131072
    s_add_u32 s33, s33, 1
    s_cmp_eq_u32 s33, 6
    s_cselect_b32 s31, 4294844416, s40
    s_cselect_b32 s33, 0, s33
    s_add_u32 s30, s30, s31

    s_add_u32 m0, s30, 0
    s_add_u32 s31, s28, 0
    buffer_load_dwordx4 v48, s[4:7], s31 offen lds
    s_add_u32 m0, s30, 4096
    s_add_u32 s31, s28, 229376
    buffer_load_dwordx4 v48, s[4:7], s31 offen lds
    s_add_u32 m0, s30, 8192
    s_add_u32 s31, s28, 458752
    buffer_load_dwordx4 v48, s[4:7], s31 offen lds
    s_add_u32 m0, s30, 12288
    s_add_u32 s31, s28, 688128
    buffer_load_dwordx4 v48, s[4:7], s31 offen lds
    s_add_u32 m0, s30, 16384
    s_add_u32 s31, s29, 0
    buffer_load_dwordx4 v49, s[8:11], s31 offen lds
    s_add_u32 m0, s30, 20480
    s_add_u32 s31, s29, 65536
    buffer_load_dwordx4 v49, s[8:11], s31 offen lds
    s_add_u32 s28, s28, 128
    s_add_u32 s29, s29, 131072
    s_add_u32 s33, s33, 1
    s_cmp_eq_u32 s33, 6
    s_cselect_b32 s31, 4294844416, s40
    s_cselect_b32 s33, 0, s33
    s_add_u32 s30, s30, s31

    s_waitcnt vmcnt(24)
    s_barrier
    s_mov_b32 s32, 0
w2_kernel_ploop:
    s_cmp_ge_u32 s32, 51
    s_cbranch_scc1 w2_kernel_pnoissue
    s_add_u32 m0, s30, 0
    s_add_u32 s31, s28, 0
    buffer_load_dwordx4 v48, s[4:7], s31 offen lds
    s_add_u32 m0, s30, 4096
    s_add_u32 s31, s28, 229376
    buffer_load_dwordx4 v48, s[4:7], s31 offen lds
    s_add_u32 m0, s30, 8192
    s_add_u32 s31, s28, 458752
    buffer_load_dwordx4 v48, s[4:7], s31 offen lds
    s_add_u32 m0, s30, 12288
    s_add_u32 s31, s28, 688128
    buffer_load_dwordx4 v48, s[4:7], s31 offen lds
    s_add_u32 m0, s30, 16384
    s_add_u32 s31, s29, 0
    buffer_load_dwordx4 v49, s[8:11], s31 offen lds
    s_add_u32 m0, s30, 20480
    s_add_u32 s31, s29, 65536
    buffer_load_dwordx4 v49, s[8:11], s31 offen lds
    s_add_u32 s28, s28, 128
    s_add_u32 s29, s29, 131072
    s_add_u32 s33, s33, 1
    s_cmp_eq_u32 s33, 6
    s_cselect_b32 s31, 4294844416, s40
    s_cselect_b32 s33, 0, s33
    s_add_u32 s30, s30, s31

    s_waitcnt vmcnt(24)
    s_branch w2_kernel_pbar
w2_kernel_pnoissue:
    s_waitcnt vmcnt(0)
w2_kernel_pbar:
    s_barrier
    s_add_u32 s32, s32, 1
    s_cmp_lt_u32 s32, 55
    s_cbranch_scc1 w2_kernel_ploop
    v_mov_b32 v5, v51
    buffer_load_dwordx4 v[8:11], v5, s[20:23], 0 offen
    s_mov_b32 s35, 0
    buffer_load_dwordx4 v[104:107], v93, s[16:19], s35 offen
    s_mov_b32 s35, 16384
    buffer_load_dwordx4 v[108:111], v93, s[16:19], s35 offen
    s_waitcnt vmcnt(2)
    v_lshlrev_b32 v96, 16, v8
    v_and_b32 v97, 0xffff0000, v8
    v_lshlrev_b32 v98, 16, v9
    v_and_b32 v99, 0xffff0000, v9
    v_lshlrev_b32 v100, 16, v10
    v_and_b32 v101, 0xffff0000, v10
    v_lshlrev_b32 v102, 16, v11
    v_and_b32 v103, 0xffff0000, v11
    s_barrier
w2_kernel_epi2:
    s_barrier
    ds_read_b128 v[8:11], v92 offset:0
    ds_read_b128 v[12:15], v92 offset:16
    ds_read_b128 v[24:27], v92 offset:2176
    ds_read_b128 v[28:31], v92 offset:2192
    s_waitcnt lgkmcnt(2)
    v_pk_add_f32 v[8:9], v[8:9], v[96:97]
    v_pk_add_f32 v[10:11], v[10:11], v[98:99]
    v_pk_add_f32 v[12:13], v[12:13], v[100:101]
    v_pk_add_f32 v[14:15], v[14:15], v[102:103]
    s_waitcnt vmcnt(0)
    v_lshlrev_b32 v16, 16, v104
    v_and_b32 v17, 0xffff0000, v104
    v_lshlrev_b32 v18, 16, v105
    v_and_b32 v19, 0xffff0000, v105
    v_lshlrev_b32 v20, 16, v106
    v_and_b32 v21, 0xffff0000, v106
    v_lshlrev_b32 v22, 16, v107
    v_and_b32 v23, 0xffff0000, v107
    v_pk_add_f32 v[8:9], v[8:9], v[16:17]
    v_pk_add_f32 v[10:11], v[10:11], v[18:19]
    v_pk_add_f32 v[12:13], v[12:13], v[20:21]
    v_pk_add_f32 v[14:15], v[14:15], v[22:23]
    v_cvt_pk_bf16_f32 v16, v8, v9
    v_cvt_pk_bf16_f32 v17, v10, v11
    v_cvt_pk_bf16_f32 v18, v12, v13
    v_cvt_pk_bf16_f32 v19, v14, v15
    s_mov_b32 s35, 0
    buffer_store_dwordx4 v[16:19], v93, s[12:15], s35 offen sc1
    s_waitcnt lgkmcnt(0)
    v_pk_add_f32 v[24:25], v[24:25], v[96:97]
    v_pk_add_f32 v[26:27], v[26:27], v[98:99]
    v_pk_add_f32 v[28:29], v[28:29], v[100:101]
    v_pk_add_f32 v[30:31], v[30:31], v[102:103]
    v_lshlrev_b32 v32, 16, v108
    v_and_b32 v33, 0xffff0000, v108
    v_lshlrev_b32 v34, 16, v109
    v_and_b32 v35, 0xffff0000, v109
    v_lshlrev_b32 v36, 16, v110
    v_and_b32 v37, 0xffff0000, v110
    v_lshlrev_b32 v38, 16, v111
    v_and_b32 v39, 0xffff0000, v111
    v_pk_add_f32 v[24:25], v[24:25], v[32:33]
    v_pk_add_f32 v[26:27], v[26:27], v[34:35]
    v_pk_add_f32 v[28:29], v[28:29], v[36:37]
    v_pk_add_f32 v[30:31], v[30:31], v[38:39]
    v_cvt_pk_bf16_f32 v32, v24, v25
    v_cvt_pk_bf16_f32 v33, v26, v27
    v_cvt_pk_bf16_f32 v34, v28, v29
    v_cvt_pk_bf16_f32 v35, v30, v31
    s_mov_b32 s35, 16384
    buffer_store_dwordx4 v[32:35], v93, s[12:15], s35 offen sc1
w2_kernel_end:
    s_endpgm
.section .rodata,"a"
.p2align 6
.amdhsa_kernel qkv_kernel
  .amdhsa_next_free_vgpr 256
  .amdhsa_next_free_sgpr 102
  .amdhsa_accum_offset 256
  .amdhsa_group_segment_fixed_size 0
  .amdhsa_kernarg_size 88
  .amdhsa_user_sgpr_count 2
  .amdhsa_user_sgpr_kernarg_segment_ptr 1
  .amdhsa_system_sgpr_workgroup_id_x 1
.end_amdhsa_kernel
.p2align 6
.amdhsa_kernel attn_kernel
  .amdhsa_next_free_vgpr 256
  .amdhsa_next_free_sgpr 102
  .amdhsa_accum_offset 256
  .amdhsa_group_segment_fixed_size 0
  .amdhsa_kernarg_size 88
  .amdhsa_user_sgpr_count 2
  .amdhsa_user_sgpr_kernarg_segment_ptr 1
  .amdhsa_system_sgpr_workgroup_id_x 1
.end_amdhsa_kernel
.p2align 6
.amdhsa_kernel wo_kernel
  .amdhsa_next_free_vgpr 128
  .amdhsa_next_free_sgpr 102
  .amdhsa_accum_offset 128
  .amdhsa_group_segment_fixed_size 0
  .amdhsa_kernarg_size 88
  .amdhsa_user_sgpr_count 2
  .amdhsa_user_sgpr_kernarg_segment_ptr 1
  .amdhsa_system_sgpr_workgroup_id_x 1
.end_amdhsa_kernel
.p2align 6
.amdhsa_kernel w1_kernel
  .amdhsa_next_free_vgpr 244
  .amdhsa_next_free_sgpr 102
  .amdhsa_accum_offset 244
  .amdhsa_group_segment_fixed_size 0
  .amdhsa_kernarg_size 88
  .amdhsa_user_sgpr_count 2
  .amdhsa_user_sgpr_kernarg_segment_ptr 1
  .amdhsa_system_sgpr_workgroup_id_x 1
.end_amdhsa_kernel
.p2align 6
.amdhsa_kernel w2_kernel
  .amdhsa_next_free_vgpr 128
  .amdhsa_next_free_sgpr 102
  .amdhsa_accum_offset 128
  .amdhsa_group_segment_fixed_size 0
  .amdhsa_kernarg_size 88
  .amdhsa_user_sgpr_count 2
  .amdhsa_user_sgpr_kernarg_segment_ptr 1
  .amdhsa_system_sgpr_workgroup_id_x 1
.end_amdhsa_kernel
.p2align 6
```
